```python
import torch

def _softmax(x, axis=-1):
    return torch.softmax(x, dim=axis)
def _gelu(x):
    return torch.nn.functional.gelu(x, approximate="tanh")
def _silu(x):
    return torch.nn.functional.silu(x)
def _sigmoid(x):
    return torch.sigmoid(x)
def _layernorm(x, axis=-1, eps=1e-5):
    m = x.mean(dim=axis, keepdim=True)
    v = x.var(dim=axis, keepdim=True, unbiased=False)
    return (x - m) / torch.sqrt(v + eps)
def _scatter_add(tgt, idx, src, axis=0):
    return tgt.clone().index_add_(axis, idx, src)
def _segment_sum(src, seg, n):
    out = torch.zeros((n,) + src.shape[1:], dtype=src.dtype)
    return out.index_add_(0, seg, src)
def _pad(x, pw):
    flat = tuple(v for pair in reversed(pw) for v in pair)
    return torch.nn.functional.pad(x, flat)

kernel_name = 'gated_mix__mha_block_cached__gqa_block_cached__decode'

def setup_inputs():

    _w = (lambda a: (lambda t: t.to(torch.bfloat16) if t.is_floating_point() else t)(torch.as_tensor(a)))
    def _A_setup():
        B, Sq, D = 4, 1, 512
        H, Sk, Dh = 32, 8192, 128
        return {
            "x": _w((lambda *s: torch.randn(*s, dtype=torch.bfloat16) * 0.05)(B, Sq, D)),
            "k_cache": _w((lambda *s: torch.randn(*s, dtype=torch.bfloat16) * 6.4)(B, H, Sk, Dh)),
            "v_cache": _w((lambda *s: torch.randn(*s, dtype=torch.bfloat16) * 0.05)(B, H, Sk, Dh)),
            "wq": _w((lambda *s: torch.randn(*s, dtype=torch.bfloat16) * 6.4)(D, H * Dh) * (D ** -0.5)),
            "wo": _w((lambda *s: torch.randn(*s, dtype=torch.bfloat16) * 0.05)(H * Dh, D) * ((H * Dh) ** -0.5)),
        }
    _A_in = _A_setup()

    def _B_setup():
        B, Sq, D = 4, 1, 512
        Hq, Hkv, Sk, Dh = 32, 8, 8192, 128
        assert Hq % Hkv == 0, (Hq, Hkv)
        return {
            "x": _w((lambda *s: torch.randn(*s, dtype=torch.bfloat16) * 0.05)(B, Sq, D)),
            "k_cache": _w((lambda *s: torch.randn(*s, dtype=torch.bfloat16) * 6.4)(B, Hkv, Sk, Dh)),
            "v_cache": _w((lambda *s: torch.randn(*s, dtype=torch.bfloat16) * 0.05)(B, Hkv, Sk, Dh)),
            "wq": _w((lambda *s: torch.randn(*s, dtype=torch.bfloat16) * 6.4)(D, Hq * Dh) * (D ** -0.5)),
            "wo": _w((lambda *s: torch.randn(*s, dtype=torch.bfloat16) * 0.05)(Hq * Dh, D) * ((Hq * Dh) ** -0.5)),
        }
    _B_in = _B_setup()

    return {
        "A_x": _A_in["x"],
        "A_k_cache": _A_in["k_cache"],
        "A_v_cache": _A_in["v_cache"],
        "A_wq": _A_in["wq"],
        "A_wo": _A_in["wo"],
        "B_x": _B_in["x"],
        "B_k_cache": _B_in["k_cache"],
        "B_v_cache": _B_in["v_cache"],
        "B_wq": _B_in["wq"],
        "B_wo": _B_in["wo"],
        "gate_w": _w((lambda *s: torch.randn(*s, dtype=torch.bfloat16) * 0.1)(512) * 16.0),
    }

def reference(A_x, A_k_cache, A_v_cache, A_wq, A_wo, B_x, B_k_cache, B_v_cache, B_wq, B_wo, gate_w):
    def _A_ref(x, k_cache, v_cache, wq, wo):
        B, Sq, D = x.shape
        H, Dh = 32, 128
        q = (lambda x, *d: x.permute(*d))((x @ wq).reshape(B, Sq, H, Dh), 0, 2, 1, 3)
        scores = torch.einsum("bhqd,bhkd->bhqk", q, k_cache) * (Dh ** -0.5)
        p = _softmax(scores, axis=-1)
        o = torch.einsum("bhqk,bhkd->bhqd", p, v_cache)
        return (lambda x, *d: x.permute(*d))(o, 0, 2, 1, 3).reshape(B, Sq, H * Dh) @ wo

    def _B_ref(x, k_cache, v_cache, wq, wo):
        B, Sq, D = x.shape
        Hq, Dh = 32, 128
        Hkv = k_cache.shape[1]
        rep = Hq // Hkv
        q = (lambda x, *d: x.permute(*d))((x @ wq).reshape(B, Sq, Hq, Dh), 0, 2, 1, 3)
        k = (lambda x, n, axis: torch.repeat_interleave(x, n, dim=axis))(k_cache, rep, axis=1)
        v = (lambda x, n, axis: torch.repeat_interleave(x, n, dim=axis))(v_cache, rep, axis=1)
        scores = torch.einsum("bhqd,bhkd->bhqk", q, k) * (Dh ** -0.5)
        p = _softmax(scores, axis=-1)
        o = torch.einsum("bhqk,bhkd->bhqd", p, v)
        return (lambda x, *d: x.permute(*d))(o, 0, 2, 1, 3).reshape(B, Sq, Hq * Dh) @ wo

    x = A_x
    g = _sigmoid((x * gate_w).sum(-1, keepdims=True))
    a = _A_ref(x, A_k_cache, A_v_cache, A_wq, A_wo)
    b = _B_ref(x, B_k_cache, B_v_cache, B_wq, B_wo)
    return g * a + (1 - g) * b
```

```asm
; @launch grid=(256,1,1) block=(512,1,1) lds=69632
.amdgcn_target "amdgcn-amd-amdhsa--gfx950"
.text
.globl gated_mix__mha_block_cached__gqa_block_cached__decode_kernel
.p2align 8
.type gated_mix__mha_block_cached__gqa_block_cached__decode_kernel,@function
gated_mix__mha_block_cached__gqa_block_cached__decode_kernel:
  s_cmp_ge_u32 s2, 256
  s_cbranch_scc1 gated_mix__mha_block_cached__gqa_block_cached__decode_kernel_done
  s_load_dwordx16 s[4:19], s[0:1], 0
  s_load_dwordx8 s[20:27], s[0:1], 64
  s_load_dwordx4 s[28:31], s[0:1], 96
  v_lshrrev_b32 v1, 6, v0
  v_and_b32 v0, 63, v0
  v_readfirstlane_b32 s3, v1
  v_lshrrev_b32 v10, 4, v0
  v_lshrrev_b32 v11, 2, v0
  v_and_b32 v11, 3, v11
  v_and_b32 v12, 3, v0
  v_and_b32 v13, 15, v0
  v_lshlrev_b32 v2, 4, v0
  v_lshlrev_b32 v15, 10, v11
  s_lshl_b32 s85, s3, 7
  v_lshl_add_u32 v14, v10, 5, v15
  v_add_u32 v14, s85, v14
  s_and_b32 s86, s2, 7
  s_lshl_b32 s87, s86, 7
  s_lshl_b32 s88, s3, 4
  s_add_u32 s87, s87, s88
  v_lshl_add_u32 v15, v10, 2, v15
  v_add_u32 v15, s87, v15
  v_lshlrev_b32 v142, 4, v13
  v_lshl_add_u32 v143, v10, 14, v142
  v_lshl_add_u32 v145, v10, 10, v142
  v_lshl_add_u32 v142, v10, 17, v142
  s_lshr_b32 s85, s2, 4
  s_lshl_b32 s85, s85, 3
  s_and_b32 s87, s2, 7
  s_add_u32 s85, s85, s87
  s_and_b32 s85, s85, 31
  s_lshl_b32 s85, s85, 8
  s_lshl_b32 s87, s3, 19
  s_add_u32 s85, s85, s87
  s_lshl_b32 s86, s86, 3
  s_add_u32 s86, s86, s3
  s_lshl_b32 s86, s86, 16
  s_lshr_b32 s87, s2, 3
  s_lshl_b32 s87, s87, 8
  s_add_u32 s86, s86, s87
  s_lshr_b32 s80, s2, 6
  s_lshl_b32 s94, s2, 13
  s_waitcnt lgkmcnt(0)
  s_mov_b32 s64, s4
  s_and_b32 s65, s5, 0xffff
  s_mov_b32 s66, 0x1000
  s_mov_b32 s67, 0x20000
  s_mov_b32 s48, s10
  s_and_b32 s49, s11, 0xffff
  s_mov_b32 s50, 0x400000
  s_mov_b32 s51, 0x20000
  s_add_u32 s87, s80, 0
  s_and_b32 s87, s87, 3
  s_lshl_b32 s87, s87, 3
  buffer_load_dwordx2 v[236:237], v14, s[64:67], s87 offen
  s_add_u32 s87, s80, 1
  s_and_b32 s87, s87, 3
  s_lshl_b32 s87, s87, 3
  buffer_load_dwordx2 v[238:239], v14, s[64:67], s87 offen
  s_add_u32 s87, s80, 2
  s_and_b32 s87, s87, 3
  s_lshl_b32 s87, s87, 3
  buffer_load_dwordx2 v[240:241], v14, s[64:67], s87 offen
  s_add_u32 s87, s80, 3
  s_and_b32 s87, s87, 3
  s_lshl_b32 s87, s87, 3
  buffer_load_dwordx2 v[242:243], v14, s[64:67], s87 offen
  buffer_load_dword v244, v15, s[64:67], 0 offen
  s_add_u32 s87, s80, 0
  s_and_b32 s87, s87, 3
  s_lshl_b32 s87, s87, 15
  s_add_u32 s87, s87, s85
  buffer_load_dwordx4 v[164:167], v142, s[48:51], s87 offen nt
  s_add_u32 s87, s87, 8192
  buffer_load_dwordx4 v[168:171], v142, s[48:51], s87 offen nt
  s_add_u32 s87, s87, 8192
  buffer_load_dwordx4 v[172:175], v142, s[48:51], s87 offen nt
  s_add_u32 s87, s87, 8192
  buffer_load_dwordx4 v[176:179], v142, s[48:51], s87 offen nt
  s_add_u32 s87, s80, 1
  s_and_b32 s87, s87, 3
  s_lshl_b32 s87, s87, 15
  s_add_u32 s87, s87, s85
  buffer_load_dwordx4 v[180:183], v142, s[48:51], s87 offen nt
  s_add_u32 s87, s87, 8192
  buffer_load_dwordx4 v[184:187], v142, s[48:51], s87 offen nt
  s_add_u32 s87, s87, 8192
  buffer_load_dwordx4 v[188:191], v142, s[48:51], s87 offen nt
  s_add_u32 s87, s87, 8192
  buffer_load_dwordx4 v[192:195], v142, s[48:51], s87 offen nt
  s_add_u32 s87, s80, 2
  s_and_b32 s87, s87, 3
  s_lshl_b32 s87, s87, 15
  s_add_u32 s87, s87, s85
  buffer_load_dwordx4 v[196:199], v142, s[48:51], s87 offen nt
  s_add_u32 s87, s87, 8192
  buffer_load_dwordx4 v[200:203], v142, s[48:51], s87 offen nt
  s_add_u32 s87, s87, 8192
  buffer_load_dwordx4 v[204:207], v142, s[48:51], s87 offen nt
  s_add_u32 s87, s87, 8192
  buffer_load_dwordx4 v[208:211], v142, s[48:51], s87 offen nt
  s_add_u32 s87, s80, 3
  s_and_b32 s87, s87, 3
  s_lshl_b32 s87, s87, 15
  s_add_u32 s87, s87, s85
  buffer_load_dwordx4 v[212:215], v142, s[48:51], s87 offen nt
  s_add_u32 s87, s87, 8192
  buffer_load_dwordx4 v[216:219], v142, s[48:51], s87 offen nt
  s_add_u32 s87, s87, 8192
  buffer_load_dwordx4 v[220:223], v142, s[48:51], s87 offen nt
  s_add_u32 s87, s87, 8192
  buffer_load_dwordx4 v[224:227], v142, s[48:51], s87 offen nt
  s_mov_b32 s52, s20
  s_and_b32 s53, s21, 0xffff
  s_mov_b32 s54, 0x400000
  s_mov_b32 s55, 0x20000
  buffer_load_dwordx4 v[228:231], v143, s[52:55], s86 offen nt
  s_add_u32 s86, s86, 8192
  buffer_load_dwordx4 v[232:235], v143, s[52:55], s86 offen nt
  s_mov_b32 s56, s12
  s_and_b32 s57, s13, 0xffff
  s_mov_b32 s58, 0x400000
  s_mov_b32 s59, 0x20000
  s_mov_b32 s60, s22
  s_and_b32 s61, s23, 0xffff
  s_mov_b32 s62, 0x400000
  s_mov_b32 s63, 0x20000
  s_and_b32 s85, s2, 7
  s_lshl_b32 s85, s85, 2
  s_lshr_b32 s86, s2, 3
  s_and_b32 s86, s86, 3
  s_add_u32 s85, s85, s86
  s_lshl_b32 s85, s85, 4
  s_lshr_b32 s86, s2, 5
  s_and_b32 s86, s86, 1
  s_lshl_b32 s86, s86, 3
  s_add_u32 s85, s85, s86
  s_add_u32 s85, s85, s3
  s_lshl_b32 s85, s85, 13
  s_lshr_b32 s86, s2, 6
  s_lshl_b32 s86, s86, 8
  s_add_u32 s85, s85, s86
  s_add_u32 s86, s85, 4096
  buffer_load_dwordx4 v[148:151], v145, s[56:59], s85 offen nt
  buffer_load_dwordx4 v[152:155], v145, s[56:59], s86 offen nt
  buffer_load_dwordx4 v[156:159], v145, s[60:63], s85 offen nt
  buffer_load_dwordx4 v[160:163], v145, s[60:63], s86 offen nt
  s_mov_b32 s72, s30
  s_and_b32 s73, s31, 0xffff
  s_mov_b32 s74, 0x400000
  s_mov_b32 s75, 0x20000
  s_mov_b32 s68, s24
  s_and_b32 s69, s25, 0xffff
  s_mov_b32 s70, 0x400
  s_mov_b32 s71, 0x20000
  v_lshlrev_b32 v1, 8, v11
  v_lshl_add_u32 v1, v10, 6, v1
  v_lshl_add_u32 v1, v12, 4, v1
  v_and_b32 v14, 1, v12
  v_cmp_eq_u32 vcc, 0, v14
  v_mov_b32 v14, 0xffff0000
  v_mov_b32 v15, 0x0000ffff
  v_cndmask_b32 v14, v14, v15, vcc
  v_cmp_gt_u32 vcc, 2, v12
  s_nop 1
  v_cndmask_b32 v5, 0, v14, vcc
  v_cndmask_b32 v6, v14, 0, vcc
  v_mov_b32 v132, 0
  v_mov_b32 v133, 0
  v_mov_b32 v136, 0
  v_mov_b32 v137, 0
  v_mov_b32 v8, 1
  s_mov_b32 s90, 0x3db504f3
  s_mov_b32 s91, 0x3fb8aa3b
  s_mov_b32 s92, 0xbfb8aa3b
  s_mov_b32 s96, 0x01000100
  s_mov_b32 s97, 0x03020302
  s_mov_b32 s32, s6
  s_and_b32 s33, s7, 0xffff
  s_mov_b32 s34, 0x10000000
  s_mov_b32 s35, 0x20000
  s_mov_b32 s36, s8
  s_and_b32 s37, s9, 0xffff
  s_mov_b32 s38, 0x10000000
  s_mov_b32 s39, 0x20000
  s_mov_b32 s40, s16
  s_and_b32 s41, s17, 0xffff
  s_mov_b32 s42, 0x4000000
  s_mov_b32 s43, 0x20000
  s_mov_b32 s44, s18
  s_and_b32 s45, s19, 0xffff
  s_mov_b32 s46, 0x4000000
  s_mov_b32 s47, 0x20000
  s_mov_b32 s76, s26
  s_and_b32 s77, s27, 0xffff
  s_mov_b32 s78, 0x1000
  s_mov_b32 s79, 0x20000
  s_mov_b32 s4, s32
  s_mov_b32 s8, s36
  s_mov_b32 s5, s33
  s_mov_b32 s9, s37
  s_mov_b32 s6, s34
  s_mov_b32 s10, s38
  s_mov_b32 s7, 0x20000
  s_mov_b32 s11, 0x20000
  s_lshr_b32 s81, s2, 4
  s_lshl_b32 s81, s81, 3
  s_and_b32 s86, s2, 7
  s_add_u32 s81, s81, s86
  s_lshl_b32 s81, s81, 21
  s_lshr_b32 s86, s2, 3
  s_and_b32 s86, s86, 1
  s_lshl_b32 s86, s86, 20
  s_add_u32 s81, s81, s86
  s_lshl_b32 s86, s3, 12
  s_add_u32 s81, s81, s86
  s_lshr_b32 s89, s2, 3
  s_lshl_b32 s89, s89, 21
  s_add_u32 s89, s89, s86
  v_add_u32 v3, s81, v1
  v_add_u32 v4, s81, v2
  v_mov_b32 v14, 3648
  v_mov_b32 v15, 0
  ds_write_b32 v14, v15
  s_waitcnt vmcnt(21)
  v_perm_b32 v128, v236, v236, s96
  v_and_b32 v134, v128, v5
  v_and_b32 v135, v128, v6
  s_nop 1
  v_mfma_f32_16x16x32_bf16 v[108:111], v[134:137], v[164:167], 0
  v_mfma_f32_16x16x32_bf16 v[112:115], v[132:135], v[164:167], 0
  s_waitcnt vmcnt(20)
  v_perm_b32 v128, v236, v236, s97
  v_and_b32 v134, v128, v5
  v_and_b32 v135, v128, v6
  s_nop 1
  v_mfma_f32_16x16x32_bf16 v[108:111], v[134:137], v[168:171], v[108:111]
  v_mfma_f32_16x16x32_bf16 v[112:115], v[132:135], v[168:171], v[112:115]
  s_waitcnt vmcnt(19)
  v_perm_b32 v128, v237, v237, s96
  v_and_b32 v134, v128, v5
  v_and_b32 v135, v128, v6
  s_nop 1
  v_mfma_f32_16x16x32_bf16 v[108:111], v[134:137], v[172:175], v[108:111]
  v_mfma_f32_16x16x32_bf16 v[112:115], v[132:135], v[172:175], v[112:115]
  s_waitcnt vmcnt(18)
  v_perm_b32 v128, v237, v237, s97
  v_and_b32 v134, v128, v5
  v_and_b32 v135, v128, v6
  s_nop 1
  v_mfma_f32_16x16x32_bf16 v[108:111], v[134:137], v[176:179], v[108:111]
  v_mfma_f32_16x16x32_bf16 v[112:115], v[132:135], v[176:179], v[112:115]
  s_waitcnt vmcnt(17)
  v_perm_b32 v128, v238, v238, s96
  v_and_b32 v134, v128, v5
  v_and_b32 v135, v128, v6
  s_nop 1
  v_mfma_f32_16x16x32_bf16 v[108:111], v[134:137], v[180:183], v[108:111]
  v_mfma_f32_16x16x32_bf16 v[112:115], v[132:135], v[180:183], v[112:115]
  s_waitcnt vmcnt(16)
  v_perm_b32 v128, v238, v238, s97
  v_and_b32 v134, v128, v5
  v_and_b32 v135, v128, v6
  s_nop 1
  v_mfma_f32_16x16x32_bf16 v[108:111], v[134:137], v[184:187], v[108:111]
  v_mfma_f32_16x16x32_bf16 v[112:115], v[132:135], v[184:187], v[112:115]
  s_waitcnt vmcnt(15)
  v_perm_b32 v128, v239, v239, s96
  v_and_b32 v134, v128, v5
  v_and_b32 v135, v128, v6
  s_nop 1
  v_mfma_f32_16x16x32_bf16 v[108:111], v[134:137], v[188:191], v[108:111]
  v_mfma_f32_16x16x32_bf16 v[112:115], v[132:135], v[188:191], v[112:115]
  s_waitcnt vmcnt(14)
  v_perm_b32 v128, v239, v239, s97
  v_and_b32 v134, v128, v5
  v_and_b32 v135, v128, v6
  s_nop 1
  v_mfma_f32_16x16x32_bf16 v[108:111], v[134:137], v[192:195], v[108:111]
  v_mfma_f32_16x16x32_bf16 v[112:115], v[132:135], v[192:195], v[112:115]
  s_waitcnt vmcnt(13)
  v_perm_b32 v128, v240, v240, s96
  v_and_b32 v134, v128, v5
  v_and_b32 v135, v128, v6
  s_nop 1
  v_mfma_f32_16x16x32_bf16 v[108:111], v[134:137], v[196:199], v[108:111]
  v_mfma_f32_16x16x32_bf16 v[112:115], v[132:135], v[196:199], v[112:115]
  buffer_load_dwordx4 v[16:19], v3, s[32:35], 0 offen offset:0 nt
  s_waitcnt vmcnt(13)
  v_perm_b32 v128, v240, v240, s97
  v_and_b32 v134, v128, v5
  v_and_b32 v135, v128, v6
  s_nop 1
  v_mfma_f32_16x16x32_bf16 v[108:111], v[134:137], v[200:203], v[108:111]
  v_mfma_f32_16x16x32_bf16 v[112:115], v[132:135], v[200:203], v[112:115]
  buffer_load_dwordx4 v[20:23], v3, s[32:35], 0 offen offset:1024 nt
  s_waitcnt vmcnt(13)
  v_perm_b32 v128, v241, v241, s96
  v_and_b32 v134, v128, v5
  v_and_b32 v135, v128, v6
  s_nop 1
  v_mfma_f32_16x16x32_bf16 v[108:111], v[134:137], v[204:207], v[108:111]
  v_mfma_f32_16x16x32_bf16 v[112:115], v[132:135], v[204:207], v[112:115]
  buffer_load_dwordx4 v[24:27], v3, s[32:35], 0 offen offset:2048 nt
  s_waitcnt vmcnt(13)
  v_perm_b32 v128, v241, v241, s97
  v_and_b32 v134, v128, v5
  v_and_b32 v135, v128, v6
  s_nop 1
  v_mfma_f32_16x16x32_bf16 v[108:111], v[134:137], v[208:211], v[108:111]
  v_mfma_f32_16x16x32_bf16 v[112:115], v[132:135], v[208:211], v[112:115]
  buffer_load_dwordx4 v[28:31], v3, s[32:35], 0 offen offset:3072 nt
  s_waitcnt vmcnt(13)
  v_perm_b32 v128, v242, v242, s96
  v_and_b32 v134, v128, v5
  v_and_b32 v135, v128, v6
  s_nop 1
  v_mfma_f32_16x16x32_bf16 v[108:111], v[134:137], v[212:215], v[108:111]
  v_mfma_f32_16x16x32_bf16 v[112:115], v[132:135], v[212:215], v[112:115]
  buffer_load_dwordx4 v[32:35], v4, s[36:39], 0 offen offset:0 nt
  s_waitcnt vmcnt(13)
  v_perm_b32 v128, v242, v242, s97
  v_and_b32 v134, v128, v5
  v_and_b32 v135, v128, v6
  s_nop 1
  v_mfma_f32_16x16x32_bf16 v[108:111], v[134:137], v[216:219], v[108:111]
  v_mfma_f32_16x16x32_bf16 v[112:115], v[132:135], v[216:219], v[112:115]
  buffer_load_dwordx4 v[36:39], v4, s[36:39], 0 offen offset:1024 nt
  s_waitcnt vmcnt(13)
  v_perm_b32 v128, v243, v243, s96
  v_and_b32 v134, v128, v5
  v_and_b32 v135, v128, v6
  s_nop 1
  v_mfma_f32_16x16x32_bf16 v[108:111], v[134:137], v[220:223], v[108:111]
  v_mfma_f32_16x16x32_bf16 v[112:115], v[132:135], v[220:223], v[112:115]
  buffer_load_dwordx4 v[40:43], v4, s[36:39], 0 offen offset:2048 nt
  s_waitcnt vmcnt(13)
  v_perm_b32 v128, v243, v243, s97
  v_and_b32 v134, v128, v5
  v_and_b32 v135, v128, v6
  s_nop 1
  v_mfma_f32_16x16x32_bf16 v[108:111], v[134:137], v[224:227], v[108:111]
  v_mfma_f32_16x16x32_bf16 v[112:115], v[132:135], v[224:227], v[112:115]
  buffer_load_dwordx4 v[44:47], v4, s[36:39], 0 offen offset:3072 nt
  s_waitcnt vmcnt(13)
  v_perm_b32 v128, v244, v244, s96
  v_and_b32 v134, v128, v5
  v_and_b32 v135, v128, v6
  s_nop 1
  v_mfma_f32_16x16x32_bf16 v[116:119], v[134:137], v[228:231], 0
  v_mfma_f32_16x16x32_bf16 v[120:123], v[132:135], v[228:231], 0
  s_waitcnt vmcnt(12)
  v_perm_b32 v128, v244, v244, s97
  v_and_b32 v134, v128, v5
  v_and_b32 v135, v128, v6
  s_nop 1
  v_mfma_f32_16x16x32_bf16 v[116:119], v[134:137], v[232:235], v[116:119]
  v_mfma_f32_16x16x32_bf16 v[120:123], v[132:135], v[232:235], v[120:123]
  s_lshl_b32 s85, s3, 11
  v_add_u32 v228, s85, v2
  ds_write_b128 v228, v[108:111] offset:4096
  ds_write_b128 v228, v[112:115] offset:5120
  s_nop 2
  ds_write_b128 v228, v[116:119] offset:20480
  ds_write_b128 v228, v[120:123] offset:21504
  s_waitcnt lgkmcnt(0)
  s_barrier
  s_lshl_b32 s85, s80, 8
  v_lshlrev_b32 v14, 6, v10
  v_lshl_add_u32 v14, v12, 4, v14
  v_add_u32 v14, s85, v14
  ds_read_b128 v[164:167], v14 offset:4096
  ds_read_b128 v[168:171], v14 offset:5120
  ds_read_b128 v[172:175], v14 offset:6144
  ds_read_b128 v[176:179], v14 offset:7168
  ds_read_b128 v[180:183], v14 offset:8192
  ds_read_b128 v[184:187], v14 offset:9216
  ds_read_b128 v[188:191], v14 offset:10240
  ds_read_b128 v[192:195], v14 offset:11264
  ds_read_b128 v[196:199], v14 offset:12288
  ds_read_b128 v[200:203], v14 offset:13312
  ds_read_b128 v[204:207], v14 offset:14336
  ds_read_b128 v[208:211], v14 offset:15360
  ds_read_b128 v[212:215], v14 offset:16384
  ds_read_b128 v[216:219], v14 offset:17408
  ds_read_b128 v[220:223], v14 offset:18432
  ds_read_b128 v[224:227], v14 offset:19456
  s_add_u32 s81, s81, 32768
  v_add_u32 v3, s81, v1
  v_add_u32 v4, s81, v2
  s_add_u32 s81, s81, 32768
  s_waitcnt lgkmcnt(0)
  v_add_f32 v164, v164, v196
  v_add_f32 v165, v165, v197
  v_add_f32 v166, v166, v198
  v_add_f32 v167, v167, v199
  v_add_f32 v168, v168, v200
  v_add_f32 v169, v169, v201
  v_add_f32 v170, v170, v202
  v_add_f32 v171, v171, v203
  v_add_f32 v172, v172, v204
  v_add_f32 v173, v173, v205
  v_add_f32 v174, v174, v206
  v_add_f32 v175, v175, v207
  v_add_f32 v176, v176, v208
  v_add_f32 v177, v177, v209
  v_add_f32 v178, v178, v210
  v_add_f32 v179, v179, v211
  v_add_f32 v180, v180, v212
  v_add_f32 v181, v181, v213
  v_add_f32 v182, v182, v214
  v_add_f32 v183, v183, v215
  v_add_f32 v184, v184, v216
  v_add_f32 v185, v185, v217
  v_add_f32 v186, v186, v218
  v_add_f32 v187, v187, v219
  v_add_f32 v188, v188, v220
  v_add_f32 v189, v189, v221
  v_add_f32 v190, v190, v222
  v_add_f32 v191, v191, v223
  v_add_f32 v192, v192, v224
  v_add_f32 v193, v193, v225
  v_add_f32 v194, v194, v226
  v_add_f32 v195, v195, v227
  v_add_f32 v164, v164, v180
  v_add_f32 v165, v165, v181
  v_add_f32 v166, v166, v182
  v_add_f32 v167, v167, v183
  v_add_f32 v168, v168, v184
  v_add_f32 v169, v169, v185
  v_add_f32 v170, v170, v186
  v_add_f32 v171, v171, v187
  v_add_f32 v172, v172, v188
  v_add_f32 v173, v173, v189
  v_add_f32 v174, v174, v190
  v_add_f32 v175, v175, v191
  v_add_f32 v176, v176, v192
  v_add_f32 v177, v177, v193
  v_add_f32 v178, v178, v194
  v_add_f32 v179, v179, v195
  v_add_f32 v164, v164, v172
  v_add_f32 v165, v165, v173
  v_add_f32 v166, v166, v174
  v_add_f32 v167, v167, v175
  v_add_f32 v168, v168, v176
  v_add_f32 v169, v169, v177
  v_add_f32 v170, v170, v178
  v_add_f32 v171, v171, v179
  v_cvt_pk_bf16_f32 v80, v164, v165
  v_cvt_pk_bf16_f32 v81, v166, v167
  v_cvt_pk_bf16_f32 v82, v168, v169
  v_cvt_pk_bf16_f32 v83, v170, v171
  s_add_u32 s85, s2, 0
  s_and_b32 s85, s85, 7
  s_cmp_eq_u32 s3, s85
  s_cbranch_scc0 gated_mix__mha_block_cached__gqa_block_cached__decode_kernel_nopub
  ds_read_b128 v[164:167], v2 offset:20480
  ds_read_b128 v[168:171], v2 offset:21504
  ds_read_b128 v[172:175], v2 offset:22528
  ds_read_b128 v[176:179], v2 offset:23552
  ds_read_b128 v[180:183], v2 offset:24576
  ds_read_b128 v[184:187], v2 offset:25600
  ds_read_b128 v[188:191], v2 offset:26624
  ds_read_b128 v[192:195], v2 offset:27648
  ds_read_b128 v[196:199], v2 offset:28672
  ds_read_b128 v[200:203], v2 offset:29696
  ds_read_b128 v[204:207], v2 offset:30720
  ds_read_b128 v[208:211], v2 offset:31744
  ds_read_b128 v[212:215], v2 offset:32768
  ds_read_b128 v[216:219], v2 offset:33792
  ds_read_b128 v[220:223], v2 offset:34816
  ds_read_b128 v[224:227], v2 offset:35840
  s_lshl_b32 s85, s2, 11
  s_add_u32 s85, s85, 2097152
  v_lshlrev_b32 v14, 5, v13
  v_lshl_add_u32 v14, v10, 9, v14
  v_add_u32 v14, s85, v14
  s_waitcnt lgkmcnt(0)
  v_add_f32 v164, v164, v196
  v_add_f32 v165, v165, v197
  v_add_f32 v166, v166, v198
  v_add_f32 v167, v167, v199
  v_add_f32 v168, v168, v200
  v_add_f32 v169, v169, v201
  v_add_f32 v170, v170, v202
  v_add_f32 v171, v171, v203
  v_add_f32 v172, v172, v204
  v_add_f32 v173, v173, v205
  v_add_f32 v174, v174, v206
  v_add_f32 v175, v175, v207
  v_add_f32 v176, v176, v208
  v_add_f32 v177, v177, v209
  v_add_f32 v178, v178, v210
  v_add_f32 v179, v179, v211
  v_add_f32 v180, v180, v212
  v_add_f32 v181, v181, v213
  v_add_f32 v182, v182, v214
  v_add_f32 v183, v183, v215
  v_add_f32 v184, v184, v216
  v_add_f32 v185, v185, v217
  v_add_f32 v186, v186, v218
  v_add_f32 v187, v187, v219
  v_add_f32 v188, v188, v220
  v_add_f32 v189, v189, v221
  v_add_f32 v190, v190, v222
  v_add_f32 v191, v191, v223
  v_add_f32 v192, v192, v224
  v_add_f32 v193, v193, v225
  v_add_f32 v194, v194, v226
  v_add_f32 v195, v195, v227
  v_add_f32 v164, v164, v180
  v_add_f32 v165, v165, v181
  v_add_f32 v166, v166, v182
  v_add_f32 v167, v167, v183
  v_add_f32 v168, v168, v184
  v_add_f32 v169, v169, v185
  v_add_f32 v170, v170, v186
  v_add_f32 v171, v171, v187
  v_add_f32 v172, v172, v188
  v_add_f32 v173, v173, v189
  v_add_f32 v174, v174, v190
  v_add_f32 v175, v175, v191
  v_add_f32 v176, v176, v192
  v_add_f32 v177, v177, v193
  v_add_f32 v178, v178, v194
  v_add_f32 v179, v179, v195
  v_add_f32 v164, v164, v172
  v_add_f32 v165, v165, v173
  v_add_f32 v166, v166, v174
  v_add_f32 v167, v167, v175
  v_add_f32 v168, v168, v176
  v_add_f32 v169, v169, v177
  v_add_f32 v170, v170, v178
  v_add_f32 v171, v171, v179
  buffer_store_dwordx4 v[164:167], v14, s[72:75], 0 offen sc1
  buffer_store_dwordx4 v[168:171], v14, s[72:75], 0 offen offset:16 sc1
  v_mov_b32 v128, -1
  v_mov_b32 v129, -1
  v_mov_b32 v130, -1
  v_mov_b32 v131, -1
  v_add_u32 v14, s94, v2
  buffer_store_dwordx4 v[128:131], v14, s[72:75], 0 offen offset:0 sc1
  buffer_store_dwordx4 v[128:131], v14, s[72:75], 0 offen offset:1024 sc1
  buffer_store_dwordx4 v[128:131], v14, s[72:75], 0 offen offset:2048 sc1
  buffer_store_dwordx4 v[128:131], v14, s[72:75], 0 offen offset:3072 sc1
  s_nop 1
  v_add_u32 v14, 4096, v14
  buffer_store_dwordx4 v[128:131], v14, s[72:75], 0 offen sc1
  s_and_b32 s85, s2, 7
  s_cmp_eq_u32 s85, 0
  s_cbranch_scc0 gated_mix__mha_block_cached__gqa_block_cached__decode_kernel_noclr
  s_lshl_b32 s85, s2, 8
  s_add_u32 s85, s85, 3145728
  v_lshlrev_b32 v14, 8, v0
  v_add_u32 v14, s85, v14
  v_mov_b32 v15, 0
  s_mov_b64 exec, 0xff
  buffer_store_dword v15, v14, s[72:75], 0 offen sc1
  s_mov_b64 exec, -1
gated_mix__mha_block_cached__gqa_block_cached__decode_kernel_noclr:
  s_waitcnt vmcnt(9)
  buffer_load_dwordx4 v[48:51], v3, s[32:35], 0 offen offset:0 nt
  s_waitcnt vmcnt(9)
  buffer_load_dwordx4 v[52:55], v3, s[32:35], 0 offen offset:1024 nt
  s_waitcnt vmcnt(9)
  buffer_load_dwordx4 v[56:59], v3, s[32:35], 0 offen offset:2048 nt
  s_waitcnt vmcnt(9)
  buffer_load_dwordx4 v[60:63], v3, s[32:35], 0 offen offset:3072 nt
  s_waitcnt vmcnt(9)
  buffer_load_dwordx4 v[64:67], v4, s[36:39], 0 offen offset:0 nt
  s_waitcnt vmcnt(9)
  buffer_load_dwordx4 v[68:71], v4, s[36:39], 0 offen offset:1024 nt
  s_waitcnt vmcnt(9)
  buffer_load_dwordx4 v[72:75], v4, s[36:39], 0 offen offset:2048 nt
  s_waitcnt vmcnt(9)
  buffer_load_dwordx4 v[76:79], v4, s[36:39], 0 offen offset:3072 nt
  s_branch gated_mix__mha_block_cached__gqa_block_cached__decode_kernel_t1d
gated_mix__mha_block_cached__gqa_block_cached__decode_kernel_nopub:
  s_waitcnt vmcnt(2)
  buffer_load_dwordx4 v[48:51], v3, s[32:35], 0 offen offset:0 nt
  s_waitcnt vmcnt(2)
  buffer_load_dwordx4 v[52:55], v3, s[32:35], 0 offen offset:1024 nt
  s_waitcnt vmcnt(2)
  buffer_load_dwordx4 v[56:59], v3, s[32:35], 0 offen offset:2048 nt
  s_waitcnt vmcnt(2)
  buffer_load_dwordx4 v[60:63], v3, s[32:35], 0 offen offset:3072 nt
  s_waitcnt vmcnt(2)
  buffer_load_dwordx4 v[64:67], v4, s[36:39], 0 offen offset:0 nt
  s_waitcnt vmcnt(2)
  buffer_load_dwordx4 v[68:71], v4, s[36:39], 0 offen offset:1024 nt
  s_waitcnt vmcnt(2)
  buffer_load_dwordx4 v[72:75], v4, s[36:39], 0 offen offset:2048 nt
  s_waitcnt vmcnt(2)
  buffer_load_dwordx4 v[76:79], v4, s[36:39], 0 offen offset:3072 nt
gated_mix__mha_block_cached__gqa_block_cached__decode_kernel_t1d:
  v_mov_b32 v88, 0
  v_mov_b32 v89, 0
  v_mov_b32 v90, 0
  v_mov_b32 v91, 0
  v_mov_b32 v92, 0
  v_mov_b32 v93, 0
  v_mov_b32 v94, 0
  v_mov_b32 v95, 0
  v_mov_b32 v104, 0xff7fffff
  v_mov_b32 v105, 0
  s_mov_b32 s82, 0
gated_mix__mha_block_cached__gqa_block_cached__decode_kernel_sloop:
  s_cmp_eq_u32 s82, 0
  s_cbranch_scc1 gated_mix__mha_block_cached__gqa_block_cached__decode_kernel_job0
  s_cmp_eq_u32 s82, 2
  s_cbranch_scc1 gated_mix__mha_block_cached__gqa_block_cached__decode_kernel_job2
  s_cmp_eq_u32 s82, 4
  s_cbranch_scc1 gated_mix__mha_block_cached__gqa_block_cached__decode_kernel_jobp
  s_cmp_eq_u32 s82, 6
  s_cbranch_scc1 gated_mix__mha_block_cached__gqa_block_cached__decode_kernel_jobg
gated_mix__mha_block_cached__gqa_block_cached__decode_kernel_jobret:
  v_add_u32 v3, s81, v1
  v_add_u32 v4, s81, v2
  s_add_u32 s81, s81, 32768
  s_waitcnt vmcnt(12)
  v_mfma_f32_16x16x32_bf16 v[108:111], v[16:19], v[80:83], 0
  v_mfma_f32_16x16x32_bf16 v[112:115], v[20:23], v[80:83], 0
  v_mfma_f32_16x16x32_bf16 v[116:119], v[24:27], v[80:83], 0
  v_mfma_f32_16x16x32_bf16 v[120:123], v[28:31], v[80:83], 0
  s_waitcnt vmcnt(2)
  buffer_load_dwordx4 v[16:19], v3, s[32:35], 0 offen offset:0 nt
  s_nop 2
  v_mov_b32_dpp v124, v108 quad_perm:[0,0,0,0] row_mask:0xf bank_mask:0xf
  v_mov_b32_dpp v125, v112 quad_perm:[0,0,0,0] row_mask:0xf bank_mask:0xf
  s_nop 0
  v_add_f32_dpp v124, v109, v124 quad_perm:[1,1,1,1] row_mask:0xf bank_mask:0xf
  v_add_f32_dpp v125, v113, v125 quad_perm:[1,1,1,1] row_mask:0xf bank_mask:0xf
  s_nop 0
  v_add_f32_dpp v124, v110, v124 quad_perm:[2,2,2,2] row_mask:0xf bank_mask:0xf
  v_add_f32_dpp v125, v114, v125 quad_perm:[2,2,2,2] row_mask:0xf bank_mask:0xf
  s_nop 0
  v_add_f32_dpp v124, v111, v124 quad_perm:[3,3,3,3] row_mask:0xf bank_mask:0xf
  v_add_f32_dpp v125, v115, v125 quad_perm:[3,3,3,3] row_mask:0xf bank_mask:0xf
  s_waitcnt vmcnt(2)
  buffer_load_dwordx4 v[20:23], v3, s[32:35], 0 offen offset:1024 nt
  v_mov_b32_dpp v126, v116 quad_perm:[0,0,0,0] row_mask:0xf bank_mask:0xf
  v_mov_b32_dpp v127, v120 quad_perm:[0,0,0,0] row_mask:0xf bank_mask:0xf
  s_nop 0
  v_add_f32_dpp v126, v117, v126 quad_perm:[1,1,1,1] row_mask:0xf bank_mask:0xf
  v_add_f32_dpp v127, v121, v127 quad_perm:[1,1,1,1] row_mask:0xf bank_mask:0xf
  s_nop 0
  v_add_f32_dpp v126, v118, v126 quad_perm:[2,2,2,2] row_mask:0xf bank_mask:0xf
  v_add_f32_dpp v127, v122, v127 quad_perm:[2,2,2,2] row_mask:0xf bank_mask:0xf
  s_nop 0
  v_add_f32_dpp v126, v119, v126 quad_perm:[3,3,3,3] row_mask:0xf bank_mask:0xf
  v_add_f32_dpp v127, v123, v127 quad_perm:[3,3,3,3] row_mask:0xf bank_mask:0xf
  v_cvt_pk_bf16_f32 v142, v124, v125
  v_cvt_pk_bf16_f32 v143, v126, v127
  v_lshlrev_b32 v124, 16, v142
  v_and_b32 v125, 0xffff0000, v142
  v_lshlrev_b32 v126, 16, v143
  v_and_b32 v127, 0xffff0000, v143
  s_waitcnt vmcnt(2)
  buffer_load_dwordx4 v[24:27], v3, s[32:35], 0 offen offset:2048 nt
  v_mul_f32 v124, s90, v124
  v_mul_f32 v125, s90, v125
  v_mul_f32 v126, s90, v126
  v_mul_f32 v127, s90, v127
  v_cvt_pk_bf16_f32 v142, v124, v125
  v_cvt_pk_bf16_f32 v143, v126, v127
  v_lshlrev_b32 v124, 16, v142
  v_and_b32 v125, 0xffff0000, v142
  v_lshlrev_b32 v126, 16, v143
  v_and_b32 v127, 0xffff0000, v143
  v_max3_f32 v144, v124, v125, v126
  v_max_f32 v144, v144, v127
  v_mov_b32 v145, v144
  s_nop 1
  v_permlane16_swap_b32 v144, v145
  v_max_f32 v144, v144, v145
  v_mov_b32 v145, v144
  s_nop 1
  v_permlane32_swap_b32 v144, v145
  v_max_f32 v144, v144, v145
  v_max_f32 v141, v104, v144
  s_waitcnt vmcnt(2)
  buffer_load_dwordx4 v[28:31], v3, s[32:35], 0 offen offset:3072 nt
  v_sub_f32 v138, v104, v141
  v_mul_f32 v140, s92, v141
  v_mul_f32 v138, s91, v138
  v_fma_f32 v124, v124, s91, v140
  v_fma_f32 v125, v125, s91, v140
  v_fma_f32 v126, v126, s91, v140
  v_fma_f32 v127, v127, s91, v140
  v_exp_f32 v138, v138
  v_exp_f32 v124, v124
  v_exp_f32 v125, v125
  v_exp_f32 v126, v126
  v_exp_f32 v127, v127
  v_mov_b32 v104, v141
  v_mov_b32_dpp v139, v138 row_newbcast:0 row_mask:0x1 bank_mask:0xf
  s_nop 1
  v_mov_b32_dpp v139, v138 row_newbcast:4 row_mask:0x2 bank_mask:0xf
  s_nop 1
  v_mov_b32_dpp v139, v138 row_newbcast:8 row_mask:0x4 bank_mask:0xf
  s_nop 1
  v_mov_b32_dpp v139, v138 row_newbcast:12 row_mask:0x8 bank_mask:0xf
  v_fma_f32 v105, v105, v138, v124
  v_cvt_pk_bf16_f32 v128, v124, v124
  v_cvt_pk_bf16_f32 v129, v125, v125
  v_cvt_pk_bf16_f32 v130, v126, v126
  v_cvt_pk_bf16_f32 v131, v127, v127
  v_add_f32 v142, v125, v126
  v_add_f32 v105, v105, v127
  v_add_f32 v105, v105, v142
  v_mul_f32 v88, v88, v139
  v_mul_f32 v89, v89, v139
  v_mul_f32 v90, v90, v139
  v_mul_f32 v91, v91, v139
  v_mul_f32 v92, v92, v139
  v_mul_f32 v93, v93, v139
  v_mul_f32 v94, v94, v139
  v_mul_f32 v95, v95, v139
  s_waitcnt vmcnt(12)
  v_and_b32 v134, v128, v5
  v_and_b32 v135, v128, v6
  s_nop 1
  v_mfma_f32_16x16x32_bf16 v[88:91], v[134:137], v[32:35], v[88:91]
  v_mfma_f32_16x16x32_bf16 v[92:95], v[132:135], v[32:35], v[92:95]
  s_waitcnt vmcnt(2)
  buffer_load_dwordx4 v[32:35], v4, s[36:39], 0 offen offset:0 nt
  v_and_b32 v134, v129, v5
  v_and_b32 v135, v129, v6
  s_nop 1
  v_mfma_f32_16x16x32_bf16 v[88:91], v[134:137], v[36:39], v[88:91]
  v_mfma_f32_16x16x32_bf16 v[92:95], v[132:135], v[36:39], v[92:95]
  s_waitcnt vmcnt(2)
  buffer_load_dwordx4 v[36:39], v4, s[36:39], 0 offen offset:1024 nt
  v_and_b32 v134, v130, v5
  v_and_b32 v135, v130, v6
  s_nop 1
  v_mfma_f32_16x16x32_bf16 v[88:91], v[134:137], v[40:43], v[88:91]
  v_mfma_f32_16x16x32_bf16 v[92:95], v[132:135], v[40:43], v[92:95]
  s_waitcnt vmcnt(2)
  buffer_load_dwordx4 v[40:43], v4, s[36:39], 0 offen offset:2048 nt
  v_and_b32 v134, v131, v5
  v_and_b32 v135, v131, v6
  s_nop 1
  v_mfma_f32_16x16x32_bf16 v[88:91], v[134:137], v[44:47], v[88:91]
  v_mfma_f32_16x16x32_bf16 v[92:95], v[132:135], v[44:47], v[92:95]
  s_waitcnt vmcnt(2)
  buffer_load_dwordx4 v[44:47], v4, s[36:39], 0 offen offset:3072 nt
  v_add_u32 v3, s81, v1
  v_add_u32 v4, s81, v2
  s_add_u32 s81, s81, 32768
  s_waitcnt vmcnt(12)
  v_mfma_f32_16x16x32_bf16 v[108:111], v[48:51], v[80:83], 0
  v_mfma_f32_16x16x32_bf16 v[112:115], v[52:55], v[80:83], 0
  v_mfma_f32_16x16x32_bf16 v[116:119], v[56:59], v[80:83], 0
  v_mfma_f32_16x16x32_bf16 v[120:123], v[60:63], v[80:83], 0
  s_waitcnt vmcnt(2)
  buffer_load_dwordx4 v[48:51], v3, s[32:35], 0 offen offset:0 nt
  s_nop 2
  v_mov_b32_dpp v124, v108 quad_perm:[0,0,0,0] row_mask:0xf bank_mask:0xf
  v_mov_b32_dpp v125, v112 quad_perm:[0,0,0,0] row_mask:0xf bank_mask:0xf
  s_nop 0
  v_add_f32_dpp v124, v109, v124 quad_perm:[1,1,1,1] row_mask:0xf bank_mask:0xf
  v_add_f32_dpp v125, v113, v125 quad_perm:[1,1,1,1] row_mask:0xf bank_mask:0xf
  s_nop 0
  v_add_f32_dpp v124, v110, v124 quad_perm:[2,2,2,2] row_mask:0xf bank_mask:0xf
  v_add_f32_dpp v125, v114, v125 quad_perm:[2,2,2,2] row_mask:0xf bank_mask:0xf
  s_nop 0
  v_add_f32_dpp v124, v111, v124 quad_perm:[3,3,3,3] row_mask:0xf bank_mask:0xf
  v_add_f32_dpp v125, v115, v125 quad_perm:[3,3,3,3] row_mask:0xf bank_mask:0xf
  s_waitcnt vmcnt(2)
  buffer_load_dwordx4 v[52:55], v3, s[32:35], 0 offen offset:1024 nt
  v_mov_b32_dpp v126, v116 quad_perm:[0,0,0,0] row_mask:0xf bank_mask:0xf
  v_mov_b32_dpp v127, v120 quad_perm:[0,0,0,0] row_mask:0xf bank_mask:0xf
  s_nop 0
  v_add_f32_dpp v126, v117, v126 quad_perm:[1,1,1,1] row_mask:0xf bank_mask:0xf
  v_add_f32_dpp v127, v121, v127 quad_perm:[1,1,1,1] row_mask:0xf bank_mask:0xf
  s_nop 0
  v_add_f32_dpp v126, v118, v126 quad_perm:[2,2,2,2] row_mask:0xf bank_mask:0xf
  v_add_f32_dpp v127, v122, v127 quad_perm:[2,2,2,2] row_mask:0xf bank_mask:0xf
  s_nop 0
  v_add_f32_dpp v126, v119, v126 quad_perm:[3,3,3,3] row_mask:0xf bank_mask:0xf
  v_add_f32_dpp v127, v123, v127 quad_perm:[3,3,3,3] row_mask:0xf bank_mask:0xf
  v_cvt_pk_bf16_f32 v142, v124, v125
  v_cvt_pk_bf16_f32 v143, v126, v127
  v_lshlrev_b32 v124, 16, v142
  v_and_b32 v125, 0xffff0000, v142
  v_lshlrev_b32 v126, 16, v143
  v_and_b32 v127, 0xffff0000, v143
  s_waitcnt vmcnt(2)
  buffer_load_dwordx4 v[56:59], v3, s[32:35], 0 offen offset:2048 nt
  v_mul_f32 v124, s90, v124
  v_mul_f32 v125, s90, v125
  v_mul_f32 v126, s90, v126
  v_mul_f32 v127, s90, v127
  v_cvt_pk_bf16_f32 v142, v124, v125
  v_cvt_pk_bf16_f32 v143, v126, v127
  v_lshlrev_b32 v124, 16, v142
  v_and_b32 v125, 0xffff0000, v142
  v_lshlrev_b32 v126, 16, v143
  v_and_b32 v127, 0xffff0000, v143
  v_max3_f32 v144, v124, v125, v126
  v_max_f32 v144, v144, v127
  v_mov_b32 v145, v144
  s_nop 1
  v_permlane16_swap_b32 v144, v145
  v_max_f32 v144, v144, v145
  v_mov_b32 v145, v144
  s_nop 1
  v_permlane32_swap_b32 v144, v145
  v_max_f32 v144, v144, v145
  v_max_f32 v141, v104, v144
  s_waitcnt vmcnt(2)
  buffer_load_dwordx4 v[60:63], v3, s[32:35], 0 offen offset:3072 nt
  v_sub_f32 v138, v104, v141
  v_mul_f32 v140, s92, v141
  v_mul_f32 v138, s91, v138
  v_fma_f32 v124, v124, s91, v140
  v_fma_f32 v125, v125, s91, v140
  v_fma_f32 v126, v126, s91, v140
  v_fma_f32 v127, v127, s91, v140
  v_exp_f32 v138, v138
  v_exp_f32 v124, v124
  v_exp_f32 v125, v125
  v_exp_f32 v126, v126
  v_exp_f32 v127, v127
  v_mov_b32 v104, v141
  v_mov_b32_dpp v139, v138 row_newbcast:0 row_mask:0x1 bank_mask:0xf
  s_nop 1
  v_mov_b32_dpp v139, v138 row_newbcast:4 row_mask:0x2 bank_mask:0xf
  s_nop 1
  v_mov_b32_dpp v139, v138 row_newbcast:8 row_mask:0x4 bank_mask:0xf
  s_nop 1
  v_mov_b32_dpp v139, v138 row_newbcast:12 row_mask:0x8 bank_mask:0xf
  v_fma_f32 v105, v105, v138, v124
  v_cvt_pk_bf16_f32 v128, v124, v124
  v_cvt_pk_bf16_f32 v129, v125, v125
  v_cvt_pk_bf16_f32 v130, v126, v126
  v_cvt_pk_bf16_f32 v131, v127, v127
  v_add_f32 v142, v125, v126
  v_add_f32 v105, v105, v127
  v_add_f32 v105, v105, v142
  v_mul_f32 v88, v88, v139
  v_mul_f32 v89, v89, v139
  v_mul_f32 v90, v90, v139
  v_mul_f32 v91, v91, v139
  v_mul_f32 v92, v92, v139
  v_mul_f32 v93, v93, v139
  v_mul_f32 v94, v94, v139
  v_mul_f32 v95, v95, v139
  s_waitcnt vmcnt(12)
  v_and_b32 v134, v128, v5
  v_and_b32 v135, v128, v6
  s_nop 1
  v_mfma_f32_16x16x32_bf16 v[88:91], v[134:137], v[64:67], v[88:91]
  v_mfma_f32_16x16x32_bf16 v[92:95], v[132:135], v[64:67], v[92:95]
  s_waitcnt vmcnt(2)
  buffer_load_dwordx4 v[64:67], v4, s[36:39], 0 offen offset:0 nt
  v_and_b32 v134, v129, v5
  v_and_b32 v135, v129, v6
  s_nop 1
  v_mfma_f32_16x16x32_bf16 v[88:91], v[134:137], v[68:71], v[88:91]
  v_mfma_f32_16x16x32_bf16 v[92:95], v[132:135], v[68:71], v[92:95]
  s_waitcnt vmcnt(2)
  buffer_load_dwordx4 v[68:71], v4, s[36:39], 0 offen offset:1024 nt
  v_and_b32 v134, v130, v5
  v_and_b32 v135, v130, v6
  s_nop 1
  v_mfma_f32_16x16x32_bf16 v[88:91], v[134:137], v[72:75], v[88:91]
  v_mfma_f32_16x16x32_bf16 v[92:95], v[132:135], v[72:75], v[92:95]
  s_waitcnt vmcnt(2)
  buffer_load_dwordx4 v[72:75], v4, s[36:39], 0 offen offset:2048 nt
  v_and_b32 v134, v131, v5
  v_and_b32 v135, v131, v6
  s_nop 1
  v_mfma_f32_16x16x32_bf16 v[88:91], v[134:137], v[76:79], v[88:91]
  v_mfma_f32_16x16x32_bf16 v[92:95], v[132:135], v[76:79], v[92:95]
  s_waitcnt vmcnt(2)
  buffer_load_dwordx4 v[76:79], v4, s[36:39], 0 offen offset:3072 nt
  s_add_u32 s82, s82, 2
  s_cmp_lt_u32 s82, 28
  s_cbranch_scc1 gated_mix__mha_block_cached__gqa_block_cached__decode_kernel_sloop
  s_lshl_b32 s85, s3, 5
  v_lshlrev_b32 v229, 3, v11
  v_add_u32 v229, s85, v229
  s_lshl_b32 s85, s3, 6
  v_add_u32 v142, s85, v0
  v_and_b32 v143, 31, v142
  v_lshrrev_b32 v144, 5, v142
  v_and_b32 v144, 3, v144
  v_and_b32 v14, 1, v143
  v_lshlrev_b32 v14, 10, v14
  v_lshrrev_b32 v15, 1, v143
  v_lshl_add_u32 v15, v144, 4, v15
  v_lshl_add_u32 v243, v15, 4, v14
  s_cmp_eq_u32 s3, 2
  s_mov_b32 s85, 36864
  s_cmov_b32 s85, 53248
  s_mov_b32 s86, 1024
  s_cmov_b32 s86, 1280
  s_mov_b32 s87, 2048
  s_cmov_b32 s87, 4096
  s_mov_b32 s88, 4608
  s_cmov_b32 s88, 4640
  s_cselect_b32 s13, 0, -1
  s_mov_b32 s12, -1
  v_add_u32 v230, s85, v243
  v_lshlrev_b32 v231, 3, v144
  v_add_u32 v233, s88, v231
  v_add_u32 v233, s94, v233
  v_add_u32 v231, s86, v231
  v_lshlrev_b32 v244, 9, v144
  v_lshl_add_u32 v244, v143, 4, v244
  v_add_u32 v244, s94, v244
  v_add_u32 v232, s87, v244
  v_cmp_eq_u32 s[14:15], 0, v143
  s_nop 1
  s_and_b64 s[14:15], s[14:15], s[12:13]
  s_and_b32 s85, s2, 7
  s_lshr_b32 s86, s2, 3
  s_and_b32 s86, s86, 3
  s_lshr_b32 s88, s2, 5
  s_and_b32 s88, s88, 1
  s_lshl_b32 s88, s88, 8
  s_lshl_b32 s87, s85, 3
  s_add_u32 s87, s87, s3
  v_lshlrev_b32 v14, 6, v10
  v_add_u32 v235, s87, v14
  v_lshlrev_b32 v235, 13, v235
  s_lshl_b32 s87, s86, 9
  s_add_u32 s87, s87, s88
  s_add_u32 s87, s87, 2048
  v_lshl_add_u32 v234, v13, 4, v235
  v_add_u32 v234, s87, v234
  s_lshl_b32 s87, s86, 3
  s_add_u32 s87, s87, 4608
  v_add_u32 v235, s87, v235
  s_lshl_b32 s87, s85, 2
  s_add_u32 s87, s87, s86
  s_lshr_b32 s95, s87, 0
  s_and_b32 s95, s95, 7
  s_and_b32 s82, s87, 0
  s_lshl_b32 s82, s82, 4
  s_add_u32 s95, s95, s82
  s_lshr_b32 s87, s87, 3
  s_lshl_b32 s87, s87, 4
  s_add_u32 s87, s87, s95
  s_lshl_b32 s95, s3, 3
  s_add_u32 s87, s87, s95
  v_add_u32 v237, s87, v14
  v_lshlrev_b32 v237, 13, v237
  s_add_u32 s88, s88, 4096
  v_lshl_add_u32 v236, v13, 4, v237
  v_add_u32 v236, s88, v236
  v_add_u32 v237, 4640, v237
  s_lshl_b32 s87, s3, 5
  v_lshlrev_b32 v238, 3, v10
  v_add_u32 v238, s87, v238
  v_lshrrev_b32 v142, 1, v0
  v_and_b32 v142, 7, v142
  v_and_b32 v143, 1, v0
  v_lshlrev_b32 v239, 10, v142
  v_lshl_add_u32 v239, v10, 8, v239
  v_lshl_add_u32 v239, v143, 4, v239
  v_add_u32 v239, s87, v239
  v_lshlrev_b32 v240, 5, v142
  v_lshl_add_u32 v240, v10, 3, v240
  v_cmp_gt_u32 s[16:17], 2, v142
  s_lshl_b32 s85, s3, 8
  v_lshlrev_b32 v241, 5, v10
  v_lshl_add_u32 v241, v143, 4, v241
  v_add_u32 v241, s85, v241
  v_lshlrev_b32 v242, 5, v11
  v_lshl_add_u32 v242, v10, 2, v242
  v_add_u32 v242, s85, v242
  s_and_b32 s85, s2, 7
  s_lshr_b32 s86, s2, 3
  s_and_b32 s86, s86, 7
  s_lshr_b32 s87, s85, 1
  s_lshl_b32 s87, s87, 19
  s_lshl_b32 s88, s80, 9
  s_add_u32 s87, s87, s88
  s_and_b32 s88, s85, 1
  s_lshl_b32 s88, s88, 8
  s_add_u32 s87, s87, s88
  s_lshl_b32 s88, s86, 5
  s_add_u32 s87, s87, s88
  v_lshlrev_b32 v245, 13, v0
  v_add_u32 v245, s87, v245
  v_and_b32 v14, 1, v10
  v_lshlrev_b32 v14, 1, v14
  v_lshrrev_b32 v15, 1, v10
  v_add_u32 v14, v14, v15
  v_lshlrev_b32 v14, 1, v14
  s_lshl_b32 s87, s80, 10
  s_lshl_b32 s85, s85, 7
  s_lshl_b32 s86, s86, 4
  s_add_u32 s87, s87, s85
  s_add_u32 s87, s87, s86
  v_add_u32 v246, s87, v14
  s_and_b32 s85, s2, 0xf8
  s_add_u32 s85, s85, s3
  s_lshl_b32 s85, s85, 8
  s_add_u32 s101, s85, 3145728
  s_mov_b32 s93, 0
  v_mov_b32 v14, 3648
gated_mix__mha_block_cached__gqa_block_cached__decode_kernel_fl:
  ds_read_b32 v15, v14
  s_waitcnt lgkmcnt(0)
  v_readfirstlane_b32 s85, v15
  s_nop 1
  s_cmp_eq_u32 s85, 1
  s_cbranch_scc1 gated_mix__mha_block_cached__gqa_block_cached__decode_kernel_fld
  s_add_u32 s93, s93, 1
  s_cmp_gt_u32 s93, 200000
  s_cbranch_scc1 gated_mix__mha_block_cached__gqa_block_cached__decode_kernel_fld
  s_sleep 2
  s_branch gated_mix__mha_block_cached__gqa_block_cached__decode_kernel_fl
gated_mix__mha_block_cached__gqa_block_cached__decode_kernel_fld:
  ds_read_b128 v[84:87], v2 offset:0
  s_waitcnt lgkmcnt(0)
  v_add_u32 v3, s81, v1
  v_add_u32 v4, s81, v2
  s_add_u32 s81, s81, 32768
  s_waitcnt vmcnt(12)
  v_mfma_f32_16x16x32_bf16 v[108:111], v[16:19], v[80:83], 0
  v_mfma_f32_16x16x32_bf16 v[112:115], v[20:23], v[80:83], 0
  v_mfma_f32_16x16x32_bf16 v[116:119], v[24:27], v[80:83], 0
  v_mfma_f32_16x16x32_bf16 v[120:123], v[28:31], v[80:83], 0
  s_waitcnt vmcnt(2)
  buffer_load_dwordx4 v[16:19], v3, s[32:35], 0 offen offset:0 nt
  s_nop 2
  v_mov_b32_dpp v124, v108 quad_perm:[0,0,0,0] row_mask:0xf bank_mask:0xf
  v_mov_b32_dpp v125, v112 quad_perm:[0,0,0,0] row_mask:0xf bank_mask:0xf
  s_nop 0
  v_add_f32_dpp v124, v109, v124 quad_perm:[1,1,1,1] row_mask:0xf bank_mask:0xf
  v_add_f32_dpp v125, v113, v125 quad_perm:[1,1,1,1] row_mask:0xf bank_mask:0xf
  s_nop 0
  v_add_f32_dpp v124, v110, v124 quad_perm:[2,2,2,2] row_mask:0xf bank_mask:0xf
  v_add_f32_dpp v125, v114, v125 quad_perm:[2,2,2,2] row_mask:0xf bank_mask:0xf
  s_nop 0
  v_add_f32_dpp v124, v111, v124 quad_perm:[3,3,3,3] row_mask:0xf bank_mask:0xf
  v_add_f32_dpp v125, v115, v125 quad_perm:[3,3,3,3] row_mask:0xf bank_mask:0xf
  s_waitcnt vmcnt(2)
  buffer_load_dwordx4 v[20:23], v3, s[32:35], 0 offen offset:1024 nt
  v_mov_b32_dpp v126, v116 quad_perm:[0,0,0,0] row_mask:0xf bank_mask:0xf
  v_mov_b32_dpp v127, v120 quad_perm:[0,0,0,0] row_mask:0xf bank_mask:0xf
  s_nop 0
  v_add_f32_dpp v126, v117, v126 quad_perm:[1,1,1,1] row_mask:0xf bank_mask:0xf
  v_add_f32_dpp v127, v121, v127 quad_perm:[1,1,1,1] row_mask:0xf bank_mask:0xf
  s_nop 0
  v_add_f32_dpp v126, v118, v126 quad_perm:[2,2,2,2] row_mask:0xf bank_mask:0xf
  v_add_f32_dpp v127, v122, v127 quad_perm:[2,2,2,2] row_mask:0xf bank_mask:0xf
  s_nop 0
  v_add_f32_dpp v126, v119, v126 quad_perm:[3,3,3,3] row_mask:0xf bank_mask:0xf
  v_add_f32_dpp v127, v123, v127 quad_perm:[3,3,3,3] row_mask:0xf bank_mask:0xf
  v_cvt_pk_bf16_f32 v142, v124, v125
  v_cvt_pk_bf16_f32 v143, v126, v127
  v_lshlrev_b32 v124, 16, v142
  v_and_b32 v125, 0xffff0000, v142
  v_lshlrev_b32 v126, 16, v143
  v_and_b32 v127, 0xffff0000, v143
  s_waitcnt vmcnt(2)
  buffer_load_dwordx4 v[24:27], v3, s[32:35], 0 offen offset:2048 nt
  v_mul_f32 v124, s90, v124
  v_mul_f32 v125, s90, v125
  v_mul_f32 v126, s90, v126
  v_mul_f32 v127, s90, v127
  v_cvt_pk_bf16_f32 v142, v124, v125
  v_cvt_pk_bf16_f32 v143, v126, v127
  v_lshlrev_b32 v124, 16, v142
  v_and_b32 v125, 0xffff0000, v142
  v_lshlrev_b32 v126, 16, v143
  v_and_b32 v127, 0xffff0000, v143
  v_max3_f32 v144, v124, v125, v126
  v_max_f32 v144, v144, v127
  v_mov_b32 v145, v144
  s_nop 1
  v_permlane16_swap_b32 v144, v145
  v_max_f32 v144, v144, v145
  v_mov_b32 v145, v144
  s_nop 1
  v_permlane32_swap_b32 v144, v145
  v_max_f32 v144, v144, v145
  v_max_f32 v141, v104, v144
  s_waitcnt vmcnt(2)
  buffer_load_dwordx4 v[28:31], v3, s[32:35], 0 offen offset:3072 nt
  v_sub_f32 v138, v104, v141
  v_mul_f32 v140, s92, v141
  v_mul_f32 v138, s91, v138
  v_fma_f32 v124, v124, s91, v140
  v_fma_f32 v125, v125, s91, v140
  v_fma_f32 v126, v126, s91, v140
  v_fma_f32 v127, v127, s91, v140
  v_exp_f32 v138, v138
  v_exp_f32 v124, v124
  v_exp_f32 v125, v125
  v_exp_f32 v126, v126
  v_exp_f32 v127, v127
  v_mov_b32 v104, v141
  v_mov_b32_dpp v139, v138 row_newbcast:0 row_mask:0x1 bank_mask:0xf
  s_nop 1
  v_mov_b32_dpp v139, v138 row_newbcast:4 row_mask:0x2 bank_mask:0xf
  s_nop 1
  v_mov_b32_dpp v139, v138 row_newbcast:8 row_mask:0x4 bank_mask:0xf
  s_nop 1
  v_mov_b32_dpp v139, v138 row_newbcast:12 row_mask:0x8 bank_mask:0xf
  v_fma_f32 v105, v105, v138, v124
  v_cvt_pk_bf16_f32 v128, v124, v124
  v_cvt_pk_bf16_f32 v129, v125, v125
  v_cvt_pk_bf16_f32 v130, v126, v126
  v_cvt_pk_bf16_f32 v131, v127, v127
  v_add_f32 v142, v125, v126
  v_add_f32 v105, v105, v127
  v_add_f32 v105, v105, v142
  v_mul_f32 v88, v88, v139
  v_mul_f32 v89, v89, v139
  v_mul_f32 v90, v90, v139
  v_mul_f32 v91, v91, v139
  v_mul_f32 v92, v92, v139
  v_mul_f32 v93, v93, v139
  v_mul_f32 v94, v94, v139
  v_mul_f32 v95, v95, v139
  s_waitcnt vmcnt(12)
  v_and_b32 v134, v128, v5
  v_and_b32 v135, v128, v6
  s_nop 1
  v_mfma_f32_16x16x32_bf16 v[88:91], v[134:137], v[32:35], v[88:91]
  v_mfma_f32_16x16x32_bf16 v[92:95], v[132:135], v[32:35], v[92:95]
  s_waitcnt vmcnt(2)
  buffer_load_dwordx4 v[32:35], v4, s[36:39], 0 offen offset:0 nt
  v_and_b32 v134, v129, v5
  v_and_b32 v135, v129, v6
  s_nop 1
  v_mfma_f32_16x16x32_bf16 v[88:91], v[134:137], v[36:39], v[88:91]
  v_mfma_f32_16x16x32_bf16 v[92:95], v[132:135], v[36:39], v[92:95]
  s_waitcnt vmcnt(2)
  buffer_load_dwordx4 v[36:39], v4, s[36:39], 0 offen offset:1024 nt
  v_and_b32 v134, v130, v5
  v_and_b32 v135, v130, v6
  s_nop 1
  v_mfma_f32_16x16x32_bf16 v[88:91], v[134:137], v[40:43], v[88:91]
  v_mfma_f32_16x16x32_bf16 v[92:95], v[132:135], v[40:43], v[92:95]
  s_waitcnt vmcnt(2)
  buffer_load_dwordx4 v[40:43], v4, s[36:39], 0 offen offset:2048 nt
  v_and_b32 v134, v131, v5
  v_and_b32 v135, v131, v6
  s_nop 1
  v_mfma_f32_16x16x32_bf16 v[88:91], v[134:137], v[44:47], v[88:91]
  v_mfma_f32_16x16x32_bf16 v[92:95], v[132:135], v[44:47], v[92:95]
  s_waitcnt vmcnt(2)
  buffer_load_dwordx4 v[44:47], v4, s[36:39], 0 offen offset:3072 nt
  v_add_u32 v3, s81, v1
  v_add_u32 v4, s81, v2
  s_add_u32 s81, s81, 32768
  s_mov_b32 s83, 1
  s_atomic_add s83, s[30:31], s101 glc
  s_waitcnt vmcnt(12)
  v_mfma_f32_16x16x32_bf16 v[108:111], v[48:51], v[80:83], 0
  v_mfma_f32_16x16x32_bf16 v[112:115], v[52:55], v[80:83], 0
  v_mfma_f32_16x16x32_bf16 v[116:119], v[56:59], v[80:83], 0
  v_mfma_f32_16x16x32_bf16 v[120:123], v[60:63], v[80:83], 0
  s_waitcnt vmcnt(2)
  buffer_load_dwordx4 v[48:51], v3, s[32:35], 0 offen offset:0 nt
  s_nop 2
  v_mov_b32_dpp v124, v108 quad_perm:[0,0,0,0] row_mask:0xf bank_mask:0xf
  v_mov_b32_dpp v125, v112 quad_perm:[0,0,0,0] row_mask:0xf bank_mask:0xf
  s_nop 0
  v_add_f32_dpp v124, v109, v124 quad_perm:[1,1,1,1] row_mask:0xf bank_mask:0xf
  v_add_f32_dpp v125, v113, v125 quad_perm:[1,1,1,1] row_mask:0xf bank_mask:0xf
  s_nop 0
  v_add_f32_dpp v124, v110, v124 quad_perm:[2,2,2,2] row_mask:0xf bank_mask:0xf
  v_add_f32_dpp v125, v114, v125 quad_perm:[2,2,2,2] row_mask:0xf bank_mask:0xf
  s_nop 0
  v_add_f32_dpp v124, v111, v124 quad_perm:[3,3,3,3] row_mask:0xf bank_mask:0xf
  v_add_f32_dpp v125, v115, v125 quad_perm:[3,3,3,3] row_mask:0xf bank_mask:0xf
  s_waitcnt vmcnt(2)
  buffer_load_dwordx4 v[52:55], v3, s[32:35], 0 offen offset:1024 nt
  v_mov_b32_dpp v126, v116 quad_perm:[0,0,0,0] row_mask:0xf bank_mask:0xf
  v_mov_b32_dpp v127, v120 quad_perm:[0,0,0,0] row_mask:0xf bank_mask:0xf
  s_nop 0
  v_add_f32_dpp v126, v117, v126 quad_perm:[1,1,1,1] row_mask:0xf bank_mask:0xf
  v_add_f32_dpp v127, v121, v127 quad_perm:[1,1,1,1] row_mask:0xf bank_mask:0xf
  s_nop 0
  v_add_f32_dpp v126, v118, v126 quad_perm:[2,2,2,2] row_mask:0xf bank_mask:0xf
  v_add_f32_dpp v127, v122, v127 quad_perm:[2,2,2,2] row_mask:0xf bank_mask:0xf
  s_nop 0
  v_add_f32_dpp v126, v119, v126 quad_perm:[3,3,3,3] row_mask:0xf bank_mask:0xf
  v_add_f32_dpp v127, v123, v127 quad_perm:[3,3,3,3] row_mask:0xf bank_mask:0xf
  v_cvt_pk_bf16_f32 v142, v124, v125
  v_cvt_pk_bf16_f32 v143, v126, v127
  v_lshlrev_b32 v124, 16, v142
  v_and_b32 v125, 0xffff0000, v142
  v_lshlrev_b32 v126, 16, v143
  v_and_b32 v127, 0xffff0000, v143
  s_waitcnt vmcnt(2)
  buffer_load_dwordx4 v[56:59], v3, s[32:35], 0 offen offset:2048 nt
  v_mul_f32 v124, s90, v124
  v_mul_f32 v125, s90, v125
  v_mul_f32 v126, s90, v126
  v_mul_f32 v127, s90, v127
  v_cvt_pk_bf16_f32 v142, v124, v125
  v_cvt_pk_bf16_f32 v143, v126, v127
  v_lshlrev_b32 v124, 16, v142
  v_and_b32 v125, 0xffff0000, v142
  v_lshlrev_b32 v126, 16, v143
  v_and_b32 v127, 0xffff0000, v143
  v_max3_f32 v144, v124, v125, v126
  v_max_f32 v144, v144, v127
  v_mov_b32 v145, v144
  s_nop 1
  v_permlane16_swap_b32 v144, v145
  v_max_f32 v144, v144, v145
  v_mov_b32 v145, v144
  s_nop 1
  v_permlane32_swap_b32 v144, v145
  v_max_f32 v144, v144, v145
  v_max_f32 v141, v104, v144
  s_waitcnt vmcnt(2)
  buffer_load_dwordx4 v[60:63], v3, s[32:35], 0 offen offset:3072 nt
  v_sub_f32 v138, v104, v141
  v_mul_f32 v140, s92, v141
  v_mul_f32 v138, s91, v138
  v_fma_f32 v124, v124, s91, v140
  v_fma_f32 v125, v125, s91, v140
  v_fma_f32 v126, v126, s91, v140
  v_fma_f32 v127, v127, s91, v140
  v_exp_f32 v138, v138
  v_exp_f32 v124, v124
  v_exp_f32 v125, v125
  v_exp_f32 v126, v126
  v_exp_f32 v127, v127
  v_mov_b32 v104, v141
  v_mov_b32_dpp v139, v138 row_newbcast:0 row_mask:0x1 bank_mask:0xf
  s_nop 1
  v_mov_b32_dpp v139, v138 row_newbcast:4 row_mask:0x2 bank_mask:0xf
  s_nop 1
  v_mov_b32_dpp v139, v138 row_newbcast:8 row_mask:0x4 bank_mask:0xf
  s_nop 1
  v_mov_b32_dpp v139, v138 row_newbcast:12 row_mask:0x8 bank_mask:0xf
  v_fma_f32 v105, v105, v138, v124
  v_cvt_pk_bf16_f32 v128, v124, v124
  v_cvt_pk_bf16_f32 v129, v125, v125
  v_cvt_pk_bf16_f32 v130, v126, v126
  v_cvt_pk_bf16_f32 v131, v127, v127
  v_add_f32 v142, v125, v126
  v_add_f32 v105, v105, v127
  v_add_f32 v105, v105, v142
  v_mul_f32 v88, v88, v139
  v_mul_f32 v89, v89, v139
  v_mul_f32 v90, v90, v139
  v_mul_f32 v91, v91, v139
  v_mul_f32 v92, v92, v139
  v_mul_f32 v93, v93, v139
  v_mul_f32 v94, v94, v139
  v_mul_f32 v95, v95, v139
  s_waitcnt vmcnt(12)
  v_and_b32 v134, v128, v5
  v_and_b32 v135, v128, v6
  s_nop 1
  v_mfma_f32_16x16x32_bf16 v[88:91], v[134:137], v[64:67], v[88:91]
  v_mfma_f32_16x16x32_bf16 v[92:95], v[132:135], v[64:67], v[92:95]
  s_waitcnt vmcnt(2)
  buffer_load_dwordx4 v[64:67], v4, s[36:39], 0 offen offset:0 nt
  v_and_b32 v134, v129, v5
  v_and_b32 v135, v129, v6
  s_nop 1
  v_mfma_f32_16x16x32_bf16 v[88:91], v[134:137], v[68:71], v[88:91]
  v_mfma_f32_16x16x32_bf16 v[92:95], v[132:135], v[68:71], v[92:95]
  s_waitcnt vmcnt(2)
  buffer_load_dwordx4 v[68:71], v4, s[36:39], 0 offen offset:1024 nt
  v_and_b32 v134, v130, v5
  v_and_b32 v135, v130, v6
  s_nop 1
  v_mfma_f32_16x16x32_bf16 v[88:91], v[134:137], v[72:75], v[88:91]
  v_mfma_f32_16x16x32_bf16 v[92:95], v[132:135], v[72:75], v[92:95]
  s_waitcnt vmcnt(2)
  buffer_load_dwordx4 v[72:75], v4, s[36:39], 0 offen offset:2048 nt
  v_and_b32 v134, v131, v5
  v_and_b32 v135, v131, v6
  s_nop 1
  v_mfma_f32_16x16x32_bf16 v[88:91], v[134:137], v[76:79], v[88:91]
  v_mfma_f32_16x16x32_bf16 v[92:95], v[132:135], v[76:79], v[92:95]
  s_waitcnt vmcnt(2)
  buffer_load_dwordx4 v[76:79], v4, s[36:39], 0 offen offset:3072 nt
  s_mov_b32 s4, s40
  s_mov_b32 s8, s44
  s_mov_b32 s5, s41
  s_mov_b32 s9, s45
  s_mov_b32 s6, s42
  s_mov_b32 s10, s46
  s_mov_b32 s21, 2
  s_mov_b32 s0, 0
  s_mov_b32 s24, 1
  s_mov_b32 s25, 1
  s_mov_b32 s23, 0
  s_mov_b64 vcc, 0
gated_mix__mha_block_cached__gqa_block_cached__decode_kernel_dloop:
  s_cmp_eq_u32 s0, 0
  s_cbranch_scc1 gated_mix__mha_block_cached__gqa_block_cached__decode_kernel_d0_new
  s_add_u32 s95, s95, 1
  s_sub_u32 s0, s0, 1
gated_mix__mha_block_cached__gqa_block_cached__decode_kernel_d0_have:
  s_lshl_b32 s85, s95, 15
  s_add_u32 s85, s85, s89
  s_mov_b32 s26, s21
  s_mov_b32 s21, 3
  s_cmp_eq_u32 s0, 0
  s_cbranch_scc0 gated_mix__mha_block_cached__gqa_block_cached__decode_kernel_d0_go2
  s_cmp_ge_u32 s83, 20
  s_cbranch_scc1 gated_mix__mha_block_cached__gqa_block_cached__decode_kernel_d0_skip
  s_mov_b32 s83, 1
  s_atomic_add s83, s[30:31], s101 glc
gated_mix__mha_block_cached__gqa_block_cached__decode_kernel_d0_go2:
  v_add_u32 v3, s85, v1
  v_add_u32 v4, s85, v2
  s_cmp_eq_u32 s24, 2
  s_cbranch_scc1 gated_mix__mha_block_cached__gqa_block_cached__decode_kernel_d0_sw
gated_mix__mha_block_cached__gqa_block_cached__decode_kernel_d0_body:
  s_waitcnt vmcnt(12)
  v_mfma_f32_16x16x32_bf16 v[108:111], v[16:19], v[80:83], 0
  v_mfma_f32_16x16x32_bf16 v[112:115], v[20:23], v[80:83], 0
  v_mfma_f32_16x16x32_bf16 v[116:119], v[24:27], v[80:83], 0
  v_mfma_f32_16x16x32_bf16 v[120:123], v[28:31], v[80:83], 0
  s_cbranch_vccnz gated_mix__mha_block_cached__gqa_block_cached__decode_kernel_f1
  s_waitcnt vmcnt(2)
gated_mix__mha_block_cached__gqa_block_cached__decode_kernel_f1:
  buffer_load_dwordx4 v[16:19], v3, s[4:7], 0 offen offset:0 nt
  s_nop 2
  v_mov_b32_dpp v124, v108 quad_perm:[0,0,0,0] row_mask:0xf bank_mask:0xf
  v_mov_b32_dpp v125, v112 quad_perm:[0,0,0,0] row_mask:0xf bank_mask:0xf
  s_nop 0
  v_add_f32_dpp v124, v109, v124 quad_perm:[1,1,1,1] row_mask:0xf bank_mask:0xf
  v_add_f32_dpp v125, v113, v125 quad_perm:[1,1,1,1] row_mask:0xf bank_mask:0xf
  s_nop 0
  v_add_f32_dpp v124, v110, v124 quad_perm:[2,2,2,2] row_mask:0xf bank_mask:0xf
  v_add_f32_dpp v125, v114, v125 quad_perm:[2,2,2,2] row_mask:0xf bank_mask:0xf
  s_nop 0
  v_add_f32_dpp v124, v111, v124 quad_perm:[3,3,3,3] row_mask:0xf bank_mask:0xf
  v_add_f32_dpp v125, v115, v125 quad_perm:[3,3,3,3] row_mask:0xf bank_mask:0xf
  s_cbranch_vccnz gated_mix__mha_block_cached__gqa_block_cached__decode_kernel_f2
  s_waitcnt vmcnt(2)
gated_mix__mha_block_cached__gqa_block_cached__decode_kernel_f2:
  buffer_load_dwordx4 v[20:23], v3, s[4:7], 0 offen offset:1024 nt
  v_mov_b32_dpp v126, v116 quad_perm:[0,0,0,0] row_mask:0xf bank_mask:0xf
  v_mov_b32_dpp v127, v120 quad_perm:[0,0,0,0] row_mask:0xf bank_mask:0xf
  s_nop 0
  v_add_f32_dpp v126, v117, v126 quad_perm:[1,1,1,1] row_mask:0xf bank_mask:0xf
  v_add_f32_dpp v127, v121, v127 quad_perm:[1,1,1,1] row_mask:0xf bank_mask:0xf
  s_nop 0
  v_add_f32_dpp v126, v118, v126 quad_perm:[2,2,2,2] row_mask:0xf bank_mask:0xf
  v_add_f32_dpp v127, v122, v127 quad_perm:[2,2,2,2] row_mask:0xf bank_mask:0xf
  s_nop 0
  v_add_f32_dpp v126, v119, v126 quad_perm:[3,3,3,3] row_mask:0xf bank_mask:0xf
  v_add_f32_dpp v127, v123, v127 quad_perm:[3,3,3,3] row_mask:0xf bank_mask:0xf
  v_cvt_pk_bf16_f32 v142, v124, v125
  v_cvt_pk_bf16_f32 v143, v126, v127
  v_lshlrev_b32 v124, 16, v142
  v_and_b32 v125, 0xffff0000, v142
  v_lshlrev_b32 v126, 16, v143
  v_and_b32 v127, 0xffff0000, v143
  s_cbranch_vccnz gated_mix__mha_block_cached__gqa_block_cached__decode_kernel_f3
  s_waitcnt vmcnt(2)
gated_mix__mha_block_cached__gqa_block_cached__decode_kernel_f3:
  buffer_load_dwordx4 v[24:27], v3, s[4:7], 0 offen offset:2048 nt
  v_mul_f32 v124, s90, v124
  v_mul_f32 v125, s90, v125
  v_mul_f32 v126, s90, v126
  v_mul_f32 v127, s90, v127
  v_cvt_pk_bf16_f32 v142, v124, v125
  v_cvt_pk_bf16_f32 v143, v126, v127
  v_lshlrev_b32 v124, 16, v142
  v_and_b32 v125, 0xffff0000, v142
  v_lshlrev_b32 v126, 16, v143
  v_and_b32 v127, 0xffff0000, v143
  v_max3_f32 v144, v124, v125, v126
  v_max_f32 v144, v144, v127
  v_mov_b32 v145, v144
  s_nop 1
  v_permlane16_swap_b32 v144, v145
  v_max_f32 v144, v144, v145
  v_mov_b32 v145, v144
  s_nop 1
  v_permlane32_swap_b32 v144, v145
  v_max_f32 v144, v144, v145
  v_max_f32 v141, v104, v144
  s_cbranch_vccnz gated_mix__mha_block_cached__gqa_block_cached__decode_kernel_f4
  s_waitcnt vmcnt(2)
gated_mix__mha_block_cached__gqa_block_cached__decode_kernel_f4:
  buffer_load_dwordx4 v[28:31], v3, s[4:7], 0 offen offset:3072 nt
  v_sub_f32 v138, v104, v141
  v_mul_f32 v140, s92, v141
  v_mul_f32 v138, s91, v138
  v_fma_f32 v124, v124, s91, v140
  v_fma_f32 v125, v125, s91, v140
  v_fma_f32 v126, v126, s91, v140
  v_fma_f32 v127, v127, s91, v140
  v_exp_f32 v138, v138
  v_exp_f32 v124, v124
  v_exp_f32 v125, v125
  v_exp_f32 v126, v126
  v_exp_f32 v127, v127
  v_mov_b32 v104, v141
  v_mov_b32_dpp v139, v138 row_newbcast:0 row_mask:0x1 bank_mask:0xf
  s_nop 1
  v_mov_b32_dpp v139, v138 row_newbcast:4 row_mask:0x2 bank_mask:0xf
  s_nop 1
  v_mov_b32_dpp v139, v138 row_newbcast:8 row_mask:0x4 bank_mask:0xf
  s_nop 1
  v_mov_b32_dpp v139, v138 row_newbcast:12 row_mask:0x8 bank_mask:0xf
  v_fma_f32 v105, v105, v138, v124
  v_cvt_pk_bf16_f32 v128, v124, v124
  v_cvt_pk_bf16_f32 v129, v125, v125
  v_cvt_pk_bf16_f32 v130, v126, v126
  v_cvt_pk_bf16_f32 v131, v127, v127
  v_add_f32 v142, v125, v126
  v_add_f32 v105, v105, v127
  v_add_f32 v105, v105, v142
  v_mul_f32 v88, v88, v139
  v_mul_f32 v89, v89, v139
  v_mul_f32 v90, v90, v139
  v_mul_f32 v91, v91, v139
  v_mul_f32 v92, v92, v139
  v_mul_f32 v93, v93, v139
  v_mul_f32 v94, v94, v139
  v_mul_f32 v95, v95, v139
  s_waitcnt vmcnt(12)
  v_and_b32 v134, v128, v5
  v_and_b32 v135, v128, v6
  s_nop 1
  v_mfma_f32_16x16x32_bf16 v[88:91], v[134:137], v[32:35], v[88:91]
  v_mfma_f32_16x16x32_bf16 v[92:95], v[132:135], v[32:35], v[92:95]
  s_cbranch_vccnz gated_mix__mha_block_cached__gqa_block_cached__decode_kernel_f5
  s_waitcnt vmcnt(2)
gated_mix__mha_block_cached__gqa_block_cached__decode_kernel_f5:
  buffer_load_dwordx4 v[32:35], v4, s[8:11], 0 offen offset:0 nt
  v_and_b32 v134, v129, v5
  v_and_b32 v135, v129, v6
  s_nop 1
  v_mfma_f32_16x16x32_bf16 v[88:91], v[134:137], v[36:39], v[88:91]
  v_mfma_f32_16x16x32_bf16 v[92:95], v[132:135], v[36:39], v[92:95]
  s_cbranch_vccnz gated_mix__mha_block_cached__gqa_block_cached__decode_kernel_f6
  s_waitcnt vmcnt(2)
gated_mix__mha_block_cached__gqa_block_cached__decode_kernel_f6:
  buffer_load_dwordx4 v[36:39], v4, s[8:11], 0 offen offset:1024 nt
  v_and_b32 v134, v130, v5
  v_and_b32 v135, v130, v6
  s_nop 1
  v_mfma_f32_16x16x32_bf16 v[88:91], v[134:137], v[40:43], v[88:91]
  v_mfma_f32_16x16x32_bf16 v[92:95], v[132:135], v[40:43], v[92:95]
  s_cbranch_vccnz gated_mix__mha_block_cached__gqa_block_cached__decode_kernel_f7
  s_waitcnt vmcnt(2)
gated_mix__mha_block_cached__gqa_block_cached__decode_kernel_f7:
  buffer_load_dwordx4 v[40:43], v4, s[8:11], 0 offen offset:2048 nt
  v_and_b32 v134, v131, v5
  v_and_b32 v135, v131, v6
  s_nop 1
  v_mfma_f32_16x16x32_bf16 v[88:91], v[134:137], v[44:47], v[88:91]
  v_mfma_f32_16x16x32_bf16 v[92:95], v[132:135], v[44:47], v[92:95]
  s_cbranch_vccnz gated_mix__mha_block_cached__gqa_block_cached__decode_kernel_f8
  s_waitcnt vmcnt(2)
gated_mix__mha_block_cached__gqa_block_cached__decode_kernel_f8:
  buffer_load_dwordx4 v[44:47], v4, s[8:11], 0 offen offset:3072 nt
  s_mov_b32 s24, s25
  s_mov_b32 s25, s26
  s_cmp_eq_u32 s24, 0
  s_cbranch_scc1 gated_mix__mha_block_cached__gqa_block_cached__decode_kernel_dend
  s_cmp_eq_u32 s0, 0
  s_cbranch_scc1 gated_mix__mha_block_cached__gqa_block_cached__decode_kernel_d1_new
  s_add_u32 s95, s95, 1
  s_sub_u32 s0, s0, 1
gated_mix__mha_block_cached__gqa_block_cached__decode_kernel_d1_have:
  s_lshl_b32 s85, s95, 15
  s_add_u32 s85, s85, s89
  s_mov_b32 s26, s21
  s_mov_b32 s21, 3
  s_cmp_eq_u32 s0, 0
  s_cbranch_scc0 gated_mix__mha_block_cached__gqa_block_cached__decode_kernel_d1_go2
  s_cmp_ge_u32 s83, 20
  s_cbranch_scc1 gated_mix__mha_block_cached__gqa_block_cached__decode_kernel_d1_skip
  s_mov_b32 s83, 1
  s_atomic_add s83, s[30:31], s101 glc
gated_mix__mha_block_cached__gqa_block_cached__decode_kernel_d1_go2:
  v_add_u32 v3, s85, v1
  v_add_u32 v4, s85, v2
  s_cmp_eq_u32 s24, 2
  s_cbranch_scc1 gated_mix__mha_block_cached__gqa_block_cached__decode_kernel_d1_sw
gated_mix__mha_block_cached__gqa_block_cached__decode_kernel_d1_body:
  s_waitcnt vmcnt(12)
  v_mfma_f32_16x16x32_bf16 v[108:111], v[48:51], v[80:83], 0
  v_mfma_f32_16x16x32_bf16 v[112:115], v[52:55], v[80:83], 0
  v_mfma_f32_16x16x32_bf16 v[116:119], v[56:59], v[80:83], 0
  v_mfma_f32_16x16x32_bf16 v[120:123], v[60:63], v[80:83], 0
  s_cbranch_vccnz gated_mix__mha_block_cached__gqa_block_cached__decode_kernel_f9
  s_waitcnt vmcnt(2)
gated_mix__mha_block_cached__gqa_block_cached__decode_kernel_f9:
  buffer_load_dwordx4 v[48:51], v3, s[4:7], 0 offen offset:0 nt
  s_nop 2
  v_mov_b32_dpp v124, v108 quad_perm:[0,0,0,0] row_mask:0xf bank_mask:0xf
  v_mov_b32_dpp v125, v112 quad_perm:[0,0,0,0] row_mask:0xf bank_mask:0xf
  s_nop 0
  v_add_f32_dpp v124, v109, v124 quad_perm:[1,1,1,1] row_mask:0xf bank_mask:0xf
  v_add_f32_dpp v125, v113, v125 quad_perm:[1,1,1,1] row_mask:0xf bank_mask:0xf
  s_nop 0
  v_add_f32_dpp v124, v110, v124 quad_perm:[2,2,2,2] row_mask:0xf bank_mask:0xf
  v_add_f32_dpp v125, v114, v125 quad_perm:[2,2,2,2] row_mask:0xf bank_mask:0xf
  s_nop 0
  v_add_f32_dpp v124, v111, v124 quad_perm:[3,3,3,3] row_mask:0xf bank_mask:0xf
  v_add_f32_dpp v125, v115, v125 quad_perm:[3,3,3,3] row_mask:0xf bank_mask:0xf
  s_cbranch_vccnz gated_mix__mha_block_cached__gqa_block_cached__decode_kernel_f10
  s_waitcnt vmcnt(2)
gated_mix__mha_block_cached__gqa_block_cached__decode_kernel_f10:
  buffer_load_dwordx4 v[52:55], v3, s[4:7], 0 offen offset:1024 nt
  v_mov_b32_dpp v126, v116 quad_perm:[0,0,0,0] row_mask:0xf bank_mask:0xf
  v_mov_b32_dpp v127, v120 quad_perm:[0,0,0,0] row_mask:0xf bank_mask:0xf
  s_nop 0
  v_add_f32_dpp v126, v117, v126 quad_perm:[1,1,1,1] row_mask:0xf bank_mask:0xf
  v_add_f32_dpp v127, v121, v127 quad_perm:[1,1,1,1] row_mask:0xf bank_mask:0xf
  s_nop 0
  v_add_f32_dpp v126, v118, v126 quad_perm:[2,2,2,2] row_mask:0xf bank_mask:0xf
  v_add_f32_dpp v127, v122, v127 quad_perm:[2,2,2,2] row_mask:0xf bank_mask:0xf
  s_nop 0
  v_add_f32_dpp v126, v119, v126 quad_perm:[3,3,3,3] row_mask:0xf bank_mask:0xf
  v_add_f32_dpp v127, v123, v127 quad_perm:[3,3,3,3] row_mask:0xf bank_mask:0xf
  v_cvt_pk_bf16_f32 v142, v124, v125
  v_cvt_pk_bf16_f32 v143, v126, v127
  v_lshlrev_b32 v124, 16, v142
  v_and_b32 v125, 0xffff0000, v142
  v_lshlrev_b32 v126, 16, v143
  v_and_b32 v127, 0xffff0000, v143
  s_cbranch_vccnz gated_mix__mha_block_cached__gqa_block_cached__decode_kernel_f11
  s_waitcnt vmcnt(2)
gated_mix__mha_block_cached__gqa_block_cached__decode_kernel_f11:
  buffer_load_dwordx4 v[56:59], v3, s[4:7], 0 offen offset:2048 nt
  v_mul_f32 v124, s90, v124
  v_mul_f32 v125, s90, v125
  v_mul_f32 v126, s90, v126
  v_mul_f32 v127, s90, v127
  v_cvt_pk_bf16_f32 v142, v124, v125
  v_cvt_pk_bf16_f32 v143, v126, v127
  v_lshlrev_b32 v124, 16, v142
  v_and_b32 v125, 0xffff0000, v142
  v_lshlrev_b32 v126, 16, v143
  v_and_b32 v127, 0xffff0000, v143
  v_max3_f32 v144, v124, v125, v126
  v_max_f32 v144, v144, v127
  v_mov_b32 v145, v144
  s_nop 1
  v_permlane16_swap_b32 v144, v145
  v_max_f32 v144, v144, v145
  v_mov_b32 v145, v144
  s_nop 1
  v_permlane32_swap_b32 v144, v145
  v_max_f32 v144, v144, v145
  v_max_f32 v141, v104, v144
  s_cbranch_vccnz gated_mix__mha_block_cached__gqa_block_cached__decode_kernel_f12
  s_waitcnt vmcnt(2)
gated_mix__mha_block_cached__gqa_block_cached__decode_kernel_f12:
  buffer_load_dwordx4 v[60:63], v3, s[4:7], 0 offen offset:3072 nt
  v_sub_f32 v138, v104, v141
  v_mul_f32 v140, s92, v141
  v_mul_f32 v138, s91, v138
  v_fma_f32 v124, v124, s91, v140
  v_fma_f32 v125, v125, s91, v140
  v_fma_f32 v126, v126, s91, v140
  v_fma_f32 v127, v127, s91, v140
  v_exp_f32 v138, v138
  v_exp_f32 v124, v124
  v_exp_f32 v125, v125
  v_exp_f32 v126, v126
  v_exp_f32 v127, v127
  v_mov_b32 v104, v141
  v_mov_b32_dpp v139, v138 row_newbcast:0 row_mask:0x1 bank_mask:0xf
  s_nop 1
  v_mov_b32_dpp v139, v138 row_newbcast:4 row_mask:0x2 bank_mask:0xf
  s_nop 1
  v_mov_b32_dpp v139, v138 row_newbcast:8 row_mask:0x4 bank_mask:0xf
  s_nop 1
  v_mov_b32_dpp v139, v138 row_newbcast:12 row_mask:0x8 bank_mask:0xf
  v_fma_f32 v105, v105, v138, v124
  v_cvt_pk_bf16_f32 v128, v124, v124
  v_cvt_pk_bf16_f32 v129, v125, v125
  v_cvt_pk_bf16_f32 v130, v126, v126
  v_cvt_pk_bf16_f32 v131, v127, v127
  v_add_f32 v142, v125, v126
  v_add_f32 v105, v105, v127
  v_add_f32 v105, v105, v142
  v_mul_f32 v88, v88, v139
  v_mul_f32 v89, v89, v139
  v_mul_f32 v90, v90, v139
  v_mul_f32 v91, v91, v139
  v_mul_f32 v92, v92, v139
  v_mul_f32 v93, v93, v139
  v_mul_f32 v94, v94, v139
  v_mul_f32 v95, v95, v139
  s_waitcnt vmcnt(12)
  v_and_b32 v134, v128, v5
  v_and_b32 v135, v128, v6
  s_nop 1
  v_mfma_f32_16x16x32_bf16 v[88:91], v[134:137], v[64:67], v[88:91]
  v_mfma_f32_16x16x32_bf16 v[92:95], v[132:135], v[64:67], v[92:95]
  s_cbranch_vccnz gated_mix__mha_block_cached__gqa_block_cached__decode_kernel_f13
  s_waitcnt vmcnt(2)
gated_mix__mha_block_cached__gqa_block_cached__decode_kernel_f13:
  buffer_load_dwordx4 v[64:67], v4, s[8:11], 0 offen offset:0 nt
  v_and_b32 v134, v129, v5
  v_and_b32 v135, v129, v6
  s_nop 1
  v_mfma_f32_16x16x32_bf16 v[88:91], v[134:137], v[68:71], v[88:91]
  v_mfma_f32_16x16x32_bf16 v[92:95], v[132:135], v[68:71], v[92:95]
  s_cbranch_vccnz gated_mix__mha_block_cached__gqa_block_cached__decode_kernel_f14
  s_waitcnt vmcnt(2)
gated_mix__mha_block_cached__gqa_block_cached__decode_kernel_f14:
  buffer_load_dwordx4 v[68:71], v4, s[8:11], 0 offen offset:1024 nt
  v_and_b32 v134, v130, v5
  v_and_b32 v135, v130, v6
  s_nop 1
  v_mfma_f32_16x16x32_bf16 v[88:91], v[134:137], v[72:75], v[88:91]
  v_mfma_f32_16x16x32_bf16 v[92:95], v[132:135], v[72:75], v[92:95]
  s_cbranch_vccnz gated_mix__mha_block_cached__gqa_block_cached__decode_kernel_f15
  s_waitcnt vmcnt(2)
gated_mix__mha_block_cached__gqa_block_cached__decode_kernel_f15:
  buffer_load_dwordx4 v[72:75], v4, s[8:11], 0 offen offset:2048 nt
  v_and_b32 v134, v131, v5
  v_and_b32 v135, v131, v6
  s_nop 1
  v_mfma_f32_16x16x32_bf16 v[88:91], v[134:137], v[76:79], v[88:91]
  v_mfma_f32_16x16x32_bf16 v[92:95], v[132:135], v[76:79], v[92:95]
  s_cbranch_vccnz gated_mix__mha_block_cached__gqa_block_cached__decode_kernel_f16
  s_waitcnt vmcnt(2)
gated_mix__mha_block_cached__gqa_block_cached__decode_kernel_f16:
  buffer_load_dwordx4 v[76:79], v4, s[8:11], 0 offen offset:3072 nt
  s_mov_b32 s24, s25
  s_mov_b32 s25, s26
  s_cmp_eq_u32 s24, 0
  s_cbranch_scc1 gated_mix__mha_block_cached__gqa_block_cached__decode_kernel_dend
  s_branch gated_mix__mha_block_cached__gqa_block_cached__decode_kernel_dloop
gated_mix__mha_block_cached__gqa_block_cached__decode_kernel_d0_new:
  s_waitcnt lgkmcnt(0)
  s_mul_i32 s95, s83, 5
  s_mov_b32 s0, 4
  s_cmp_lt_u32 s83, 8
  s_cbranch_scc1 gated_mix__mha_block_cached__gqa_block_cached__decode_kernel_d0_have
  s_lshl_b32 s95, s83, 1
  s_add_u32 s95, s95, 24
  s_mov_b32 s0, 1
  s_cmp_lt_u32 s83, 16
  s_cbranch_scc1 gated_mix__mha_block_cached__gqa_block_cached__decode_kernel_d0_have
  s_add_u32 s95, s83, 40
  s_mov_b32 s0, 0
  s_cmp_lt_u32 s83, 24
  s_cbranch_scc1 gated_mix__mha_block_cached__gqa_block_cached__decode_kernel_d0_have
  s_mov_b32 s85, 0x7f000000
  s_mov_b32 s26, 0
  s_mov_b64 vcc, -1
  s_branch gated_mix__mha_block_cached__gqa_block_cached__decode_kernel_d0_go2
gated_mix__mha_block_cached__gqa_block_cached__decode_kernel_d0_skip:
  s_mov_b32 s83, 0x7fffffff
  s_branch gated_mix__mha_block_cached__gqa_block_cached__decode_kernel_d0_go2
gated_mix__mha_block_cached__gqa_block_cached__decode_kernel_d0_sw:
  s_nop 7
  v_mov_b32 v96, v88
  v_mov_b32 v97, v89
  v_mov_b32 v98, v90
  v_mov_b32 v99, v91
  v_mov_b32 v100, v92
  v_mov_b32 v101, v93
  v_mov_b32 v102, v94
  v_mov_b32 v103, v95
  v_mov_b32 v106, v104
  v_mov_b32 v107, v105
  v_mov_b32 v88, 0
  v_mov_b32 v89, 0
  v_mov_b32 v90, 0
  v_mov_b32 v91, 0
  v_mov_b32 v92, 0
  v_mov_b32 v93, 0
  v_mov_b32 v94, 0
  v_mov_b32 v95, 0
  v_mov_b32 v104, 0xff7fffff
  v_mov_b32 v105, 0
  v_mov_b32 v80, v84
  v_mov_b32 v81, v85
  v_mov_b32 v82, v86
  v_mov_b32 v83, v87
  s_mov_b32 s23, 1
  s_nop 1
  s_branch gated_mix__mha_block_cached__gqa_block_cached__decode_kernel_d0_body
gated_mix__mha_block_cached__gqa_block_cached__decode_kernel_d1_new:
  s_waitcnt lgkmcnt(0)
  s_mul_i32 s95, s83, 5
  s_mov_b32 s0, 4
  s_cmp_lt_u32 s83, 8
  s_cbranch_scc1 gated_mix__mha_block_cached__gqa_block_cached__decode_kernel_d1_have
  s_lshl_b32 s95, s83, 1
  s_add_u32 s95, s95, 24
  s_mov_b32 s0, 1
  s_cmp_lt_u32 s83, 16
  s_cbranch_scc1 gated_mix__mha_block_cached__gqa_block_cached__decode_kernel_d1_have
  s_add_u32 s95, s83, 40
  s_mov_b32 s0, 0
  s_cmp_lt_u32 s83, 24
  s_cbranch_scc1 gated_mix__mha_block_cached__gqa_block_cached__decode_kernel_d1_have
  s_mov_b32 s85, 0x7f000000
  s_mov_b32 s26, 0
  s_mov_b64 vcc, -1
  s_branch gated_mix__mha_block_cached__gqa_block_cached__decode_kernel_d1_go2
gated_mix__mha_block_cached__gqa_block_cached__decode_kernel_d1_skip:
  s_mov_b32 s83, 0x7fffffff
  s_branch gated_mix__mha_block_cached__gqa_block_cached__decode_kernel_d1_go2
gated_mix__mha_block_cached__gqa_block_cached__decode_kernel_d1_sw:
  s_nop 7
  v_mov_b32 v96, v88
  v_mov_b32 v97, v89
  v_mov_b32 v98, v90
  v_mov_b32 v99, v91
  v_mov_b32 v100, v92
  v_mov_b32 v101, v93
  v_mov_b32 v102, v94
  v_mov_b32 v103, v95
  v_mov_b32 v106, v104
  v_mov_b32 v107, v105
  v_mov_b32 v88, 0
  v_mov_b32 v89, 0
  v_mov_b32 v90, 0
  v_mov_b32 v91, 0
  v_mov_b32 v92, 0
  v_mov_b32 v93, 0
  v_mov_b32 v94, 0
  v_mov_b32 v95, 0
  v_mov_b32 v104, 0xff7fffff
  v_mov_b32 v105, 0
  v_mov_b32 v80, v84
  v_mov_b32 v81, v85
  v_mov_b32 v82, v86
  v_mov_b32 v83, v87
  s_mov_b32 s23, 1
  s_nop 1
  s_branch gated_mix__mha_block_cached__gqa_block_cached__decode_kernel_d1_body
gated_mix__mha_block_cached__gqa_block_cached__decode_kernel_dend:
  s_cmp_eq_u32 s23, 0
  s_cbranch_scc0 gated_mix__mha_block_cached__gqa_block_cached__decode_kernel_dend2
  s_nop 7
  v_mov_b32 v96, v88
  v_mov_b32 v97, v89
  v_mov_b32 v98, v90
  v_mov_b32 v99, v91
  v_mov_b32 v100, v92
  v_mov_b32 v101, v93
  v_mov_b32 v102, v94
  v_mov_b32 v103, v95
  v_mov_b32 v106, v104
  v_mov_b32 v107, v105
  v_mov_b32 v88, 0
  v_mov_b32 v89, 0
  v_mov_b32 v90, 0
  v_mov_b32 v91, 0
  v_mov_b32 v92, 0
  v_mov_b32 v93, 0
  v_mov_b32 v94, 0
  v_mov_b32 v95, 0
  v_mov_b32 v104, 0xff7fffff
  v_mov_b32 v105, 0
  v_mov_b32 v80, v84
  v_mov_b32 v81, v85
  v_mov_b32 v82, v86
  v_mov_b32 v83, v87
  s_mov_b32 s23, 1
gated_mix__mha_block_cached__gqa_block_cached__decode_kernel_dend2:
  s_nop 7
  ds_write_b128 v228, v[88:91] offset:36864
  ds_write_b128 v228, v[92:95] offset:37888
  ds_write_b128 v228, v[96:99] offset:53248
  ds_write_b128 v228, v[100:103] offset:54272
  v_mov_b32 v142, v105
  v_mov_b32 v143, v107
  s_nop 0
  v_permlane16_swap_b32 v105, v142
  v_permlane16_swap_b32 v107, v143
  v_add_f32 v105, v105, v142
  v_add_f32 v107, v107, v143
  v_mov_b32 v142, v105
  v_mov_b32 v143, v107
  s_nop 0
  v_permlane32_swap_b32 v105, v142
  v_permlane32_swap_b32 v107, v143
  v_add_f32 v105, v105, v142
  v_add_f32 v107, v107, v143
  ds_write_b64 v229, v[104:105] offset:1024
  ds_write_b64 v229, v[106:107] offset:1280
  s_waitcnt lgkmcnt(0)
  s_barrier
  s_cmp_lt_u32 s3, 3
  s_cbranch_scc0 gated_mix__mha_block_cached__gqa_block_cached__decode_kernel_nomerge
  s_mov_b64 exec, s[12:13]
  ds_read_b64 v[172:173], v231 offset:0
  ds_read_b64 v[174:175], v231 offset:32
  ds_read_b64 v[176:177], v231 offset:64
  ds_read_b64 v[178:179], v231 offset:96
  ds_read_b64 v[180:181], v231 offset:128
  ds_read_b64 v[182:183], v231 offset:160
  ds_read_b64 v[184:185], v231 offset:192
  ds_read_b64 v[186:187], v231 offset:224
  ds_read_b128 v[188:191], v230 offset:0
  ds_read_b128 v[192:195], v230 offset:2048
  ds_read_b128 v[196:199], v230 offset:4096
  ds_read_b128 v[200:203], v230 offset:6144
  ds_read_b128 v[204:207], v230 offset:8192
  ds_read_b128 v[208:211], v230 offset:10240
  ds_read_b128 v[212:215], v230 offset:12288
  ds_read_b128 v[216:219], v230 offset:14336
  s_waitcnt lgkmcnt(8)
  v_max3_f32 v220, v172, v174, v176
  v_max3_f32 v221, v178, v180, v182
  v_max3_f32 v220, v220, v184, v186
  v_max_f32 v220, v220, v221
  v_sub_f32 v172, v172, v220
  v_sub_f32 v174, v174, v220
  v_sub_f32 v176, v176, v220
  v_sub_f32 v178, v178, v220
  v_sub_f32 v180, v180, v220
  v_sub_f32 v182, v182, v220
  v_sub_f32 v184, v184, v220
  v_sub_f32 v186, v186, v220
  v_mul_f32 v172, s91, v172
  v_mul_f32 v174, s91, v174
  v_mul_f32 v176, s91, v176
  v_mul_f32 v178, s91, v178
  v_mul_f32 v180, s91, v180
  v_mul_f32 v182, s91, v182
  v_mul_f32 v184, s91, v184
  v_mul_f32 v186, s91, v186
  v_exp_f32 v172, v172
  v_exp_f32 v174, v174
  v_exp_f32 v176, v176
  v_exp_f32 v178, v178
  v_exp_f32 v180, v180
  v_exp_f32 v182, v182
  v_exp_f32 v184, v184
  v_exp_f32 v186, v186
  s_waitcnt lgkmcnt(0)
  v_mul_f32 v224, v172, v188
  v_mul_f32 v225, v172, v189
  v_mul_f32 v226, v172, v190
  v_mul_f32 v227, v172, v191
  v_fma_f32 v224, v174, v192, v224
  v_fma_f32 v225, v174, v193, v225
  v_fma_f32 v226, v174, v194, v226
  v_fma_f32 v227, v174, v195, v227
  v_fma_f32 v224, v176, v196, v224
  v_fma_f32 v225, v176, v197, v225
  v_fma_f32 v226, v176, v198, v226
  v_fma_f32 v227, v176, v199, v227
  v_fma_f32 v224, v178, v200, v224
  v_fma_f32 v225, v178, v201, v225
  v_fma_f32 v226, v178, v202, v226
  v_fma_f32 v227, v178, v203, v227
  v_fma_f32 v224, v180, v204, v224
  v_fma_f32 v225, v180, v205, v225
  v_fma_f32 v226, v180, v206, v226
  v_fma_f32 v227, v180, v207, v227
  v_fma_f32 v224, v182, v208, v224
  v_fma_f32 v225, v182, v209, v225
  v_fma_f32 v226, v182, v210, v226
  v_fma_f32 v227, v182, v211, v227
  v_fma_f32 v224, v184, v212, v224
  v_fma_f32 v225, v184, v213, v225
  v_fma_f32 v226, v184, v214, v226
  v_fma_f32 v227, v184, v215, v227
  v_fma_f32 v224, v186, v216, v224
  v_fma_f32 v225, v186, v217, v225
  v_fma_f32 v226, v186, v218, v226
  v_fma_f32 v227, v186, v219, v227
  buffer_store_dwordx4 v[224:227], v232, s[72:75], 0 offen sc1
  v_mul_f32 v221, v172, v173
  v_fma_f32 v221, v174, v175, v221
  v_fma_f32 v221, v176, v177, v221
  v_fma_f32 v221, v178, v179, v221
  v_fma_f32 v221, v180, v181, v221
  v_fma_f32 v221, v182, v183, v221
  v_fma_f32 v221, v184, v185, v221
  v_fma_f32 v221, v186, v187, v221
  s_mov_b64 exec, s[14:15]
  buffer_store_dwordx2 v[220:221], v233, s[72:75], 0 offen sc1
  s_mov_b64 exec, -1
  s_nop 7
gated_mix__mha_block_cached__gqa_block_cached__decode_kernel_nomerge:
  s_lshl_b32 s87, s3, 10
  v_add_u32 v142, s87, v2
  s_mov_b32 s93, 0
  s_waitcnt vmcnt(0)
  v_mov_b32 v24, 0
  v_mov_b32 v25, 0
  v_mov_b32 v26, 0
  v_mov_b32 v27, 0
  v_mov_b32 v28, 0
  v_mov_b32 v29, 0
  s_barrier
gated_mix__mha_block_cached__gqa_block_cached__decode_kernel_p1:
  buffer_load_dwordx4 v[16:19], v234, s[72:75], 0 offen sc1
  buffer_load_dwordx2 v[20:21], v235, s[72:75], 0 offen sc1
  s_cmp_lt_u32 s3, 2
  s_cbranch_scc0 gated_mix__mha_block_cached__gqa_block_cached__decode_kernel_p1n
  buffer_load_dwordx4 v[24:27], v236, s[72:75], 0 offen sc1
  buffer_load_dwordx2 v[28:29], v237, s[72:75], 0 offen sc1
gated_mix__mha_block_cached__gqa_block_cached__decode_kernel_p1n:
  s_waitcnt vmcnt(0)
  v_max3_u32 v14, v16, v17, v18
  v_max3_u32 v15, v19, v20, v21
  v_max3_u32 v14, v14, v24, v25
  v_max3_u32 v15, v15, v26, v27
  v_max3_u32 v14, v14, v28, v29
  v_max_u32 v14, v14, v15
  v_cmp_eq_u32 vcc, -1, v14
  s_nop 1
  s_cmp_eq_u64 vcc, 0
  s_cbranch_scc1 gated_mix__mha_block_cached__gqa_block_cached__decode_kernel_p1d
  s_add_u32 s93, s93, 1
  s_cmp_gt_u32 s93, 200000
  s_cbranch_scc1 gated_mix__mha_block_cached__gqa_block_cached__decode_kernel_p1d
  s_sleep 8
  s_branch gated_mix__mha_block_cached__gqa_block_cached__decode_kernel_p1
gated_mix__mha_block_cached__gqa_block_cached__decode_kernel_p1d:
  ds_write_b128 v142, v[16:19] offset:20480
  ds_write_b64 v238, v[20:21] offset:30720
  s_cmp_lt_u32 s3, 2
  s_cbranch_scc0 gated_mix__mha_block_cached__gqa_block_cached__decode_kernel_g1n
  ds_write_b128 v142, v[24:27] offset:28672
  ds_write_b64 v238, v[28:29] offset:30976
gated_mix__mha_block_cached__gqa_block_cached__decode_kernel_g1n:
  v_mov_b32 v188, 0
  v_mov_b32 v189, 0
  v_mov_b32 v190, 0
  v_mov_b32 v191, 0
  v_mov_b32 v192, 0xff7fffff
  v_mov_b32 v193, 0
  s_waitcnt lgkmcnt(0)
  s_barrier
  ds_read_b128 v[180:183], v239 offset:20480
  ds_read_b64 v[184:185], v240 offset:30720
  s_mov_b64 exec, s[16:17]
  ds_read_b128 v[188:191], v239 offset:28672
  ds_read_b64 v[192:193], v240 offset:30976
  s_mov_b64 exec, -1
  v_lshlrev_b32 v14, 3, v10
  ds_read_b64 v[204:205], v14 offset:3584
  s_waitcnt lgkmcnt(0)
  v_max_f32_dpp v196, v184, v184 row_ror:8 row_mask:0xf bank_mask:0xf
  v_max_f32_dpp v198, v192, v192 row_ror:8 row_mask:0xf bank_mask:0xf
  s_nop 0
  v_max_f32_dpp v196, v196, v196 row_ror:4 row_mask:0xf bank_mask:0xf
  v_max_f32_dpp v198, v198, v198 row_ror:4 row_mask:0xf bank_mask:0xf
  s_nop 0
  v_max_f32_dpp v196, v196, v196 row_ror:2 row_mask:0xf bank_mask:0xf
  v_max_f32_dpp v198, v198, v198 row_ror:2 row_mask:0xf bank_mask:0xf
  v_sub_f32 v197, v184, v196
  v_sub_f32 v199, v192, v198
  v_mul_f32 v197, s91, v197
  v_mul_f32 v199, s91, v199
  v_exp_f32 v197, v197
  v_exp_f32 v199, v199
  v_mul_f32 v185, v185, v197
  v_mul_f32 v193, v193, v199
  v_mul_f32 v180, v180, v197
  v_mul_f32 v181, v181, v197
  v_mul_f32 v182, v182, v197
  v_mul_f32 v183, v183, v197
  v_mul_f32 v188, v188, v199
  v_mul_f32 v189, v189, v199
  v_mul_f32 v190, v190, v199
  v_mul_f32 v191, v191, v199
  v_add_f32_dpp v185, v185, v185 row_ror:8 row_mask:0xf bank_mask:0xf
  v_add_f32_dpp v180, v180, v180 row_ror:8 row_mask:0xf bank_mask:0xf
  v_add_f32_dpp v181, v181, v181 row_ror:8 row_mask:0xf bank_mask:0xf
  v_add_f32_dpp v182, v182, v182 row_ror:8 row_mask:0xf bank_mask:0xf
  v_add_f32_dpp v183, v183, v183 row_ror:8 row_mask:0xf bank_mask:0xf
  v_add_f32_dpp v193, v193, v193 row_ror:8 row_mask:0xf bank_mask:0xf
  v_add_f32_dpp v188, v188, v188 row_ror:8 row_mask:0xf bank_mask:0xf
  v_add_f32_dpp v189, v189, v189 row_ror:8 row_mask:0xf bank_mask:0xf
  v_add_f32_dpp v190, v190, v190 row_ror:8 row_mask:0xf bank_mask:0xf
  v_add_f32_dpp v191, v191, v191 row_ror:8 row_mask:0xf bank_mask:0xf
  v_add_f32_dpp v185, v185, v185 row_ror:4 row_mask:0xf bank_mask:0xf
  v_add_f32_dpp v180, v180, v180 row_ror:4 row_mask:0xf bank_mask:0xf
  v_add_f32_dpp v181, v181, v181 row_ror:4 row_mask:0xf bank_mask:0xf
  v_add_f32_dpp v182, v182, v182 row_ror:4 row_mask:0xf bank_mask:0xf
  v_add_f32_dpp v183, v183, v183 row_ror:4 row_mask:0xf bank_mask:0xf
  v_add_f32_dpp v193, v193, v193 row_ror:4 row_mask:0xf bank_mask:0xf
  v_add_f32_dpp v188, v188, v188 row_ror:4 row_mask:0xf bank_mask:0xf
  v_add_f32_dpp v189, v189, v189 row_ror:4 row_mask:0xf bank_mask:0xf
  v_add_f32_dpp v190, v190, v190 row_ror:4 row_mask:0xf bank_mask:0xf
  v_add_f32_dpp v191, v191, v191 row_ror:4 row_mask:0xf bank_mask:0xf
  v_add_f32_dpp v185, v185, v185 row_ror:2 row_mask:0xf bank_mask:0xf
  v_add_f32_dpp v180, v180, v180 row_ror:2 row_mask:0xf bank_mask:0xf
  v_add_f32_dpp v181, v181, v181 row_ror:2 row_mask:0xf bank_mask:0xf
  v_add_f32_dpp v182, v182, v182 row_ror:2 row_mask:0xf bank_mask:0xf
  v_add_f32_dpp v183, v183, v183 row_ror:2 row_mask:0xf bank_mask:0xf
  v_add_f32_dpp v193, v193, v193 row_ror:2 row_mask:0xf bank_mask:0xf
  v_add_f32_dpp v188, v188, v188 row_ror:2 row_mask:0xf bank_mask:0xf
  v_add_f32_dpp v189, v189, v189 row_ror:2 row_mask:0xf bank_mask:0xf
  v_add_f32_dpp v190, v190, v190 row_ror:2 row_mask:0xf bank_mask:0xf
  v_add_f32_dpp v191, v191, v191 row_ror:2 row_mask:0xf bank_mask:0xf
  v_rcp_f32 v197, v185
  v_rcp_f32 v199, v193
  s_nop 0
  v_mul_f32 v188, v188, v199
  v_mul_f32 v189, v189, v199
  v_mul_f32 v190, v190, v199
  v_mul_f32 v191, v191, v199
  v_mul_f32 v180, v180, v197
  v_mul_f32 v181, v181, v197
  v_mul_f32 v182, v182, v197
  v_mul_f32 v183, v183, v197
  ds_write_b128 v241, v[188:191] offset:1536
  ds_write_b128 v241, v[180:183] offset:1664
  s_waitcnt lgkmcnt(0)
  ds_read_b32 v200, v242 offset:1536
  ds_read_b32 v201, v242 offset:1552
  ds_read_b32 v202, v242 offset:1664
  ds_read_b32 v203, v242 offset:1680
  s_waitcnt lgkmcnt(0)
  v_cvt_pk_bf16_f32 v200, v200, v200
  v_cvt_pk_bf16_f32 v201, v201, v201
  v_cvt_pk_bf16_f32 v202, v202, v202
  v_cvt_pk_bf16_f32 v203, v203, v203
  v_and_b32 v134, v200, v5
  v_and_b32 v135, v200, v6
  s_nop 1
  v_mfma_f32_16x16x32_bf16 v[108:111], v[134:137], v[148:151], 0
  v_mfma_f32_16x16x32_bf16 v[112:115], v[132:135], v[148:151], 0
  v_and_b32 v134, v202, v5
  v_and_b32 v135, v202, v6
  s_nop 1
  v_mfma_f32_16x16x32_bf16 v[116:119], v[134:137], v[156:159], 0
  v_mfma_f32_16x16x32_bf16 v[120:123], v[132:135], v[156:159], 0
  v_and_b32 v134, v201, v5
  v_and_b32 v135, v201, v6
  s_nop 1
  v_mfma_f32_16x16x32_bf16 v[108:111], v[134:137], v[152:155], v[108:111]
  v_mfma_f32_16x16x32_bf16 v[112:115], v[132:135], v[152:155], v[112:115]
  v_and_b32 v134, v203, v5
  v_and_b32 v135, v203, v6
  s_nop 1
  v_mfma_f32_16x16x32_bf16 v[116:119], v[134:137], v[160:163], v[116:119]
  v_mfma_f32_16x16x32_bf16 v[120:123], v[132:135], v[160:163], v[120:123]
  s_nop 0
  v_mul_f32 v108, v108, v204
  v_mul_f32 v109, v109, v204
  v_mul_f32 v110, v110, v204
  v_mul_f32 v111, v111, v204
  v_mul_f32 v112, v112, v204
  v_mul_f32 v113, v113, v204
  v_mul_f32 v114, v114, v204
  v_mul_f32 v115, v115, v204
  v_fma_f32 v108, v116, v205, v108
  v_fma_f32 v109, v117, v205, v109
  v_fma_f32 v110, v118, v205, v110
  v_fma_f32 v111, v119, v205, v111
  v_fma_f32 v112, v120, v205, v112
  v_fma_f32 v113, v121, v205, v113
  v_fma_f32 v114, v122, v205, v114
  v_fma_f32 v115, v123, v205, v115
  ds_write_b128 v228, v[108:111] offset:4096
  ds_write_b128 v228, v[112:115] offset:5120
  s_waitcnt lgkmcnt(0)
  s_barrier
  s_cmp_lt_u32 s3, 2
  s_cbranch_scc0 gated_mix__mha_block_cached__gqa_block_cached__decode_kernel_noy
  ds_read_b128 v[188:191], v243 offset:4096
  ds_read_b128 v[192:195], v243 offset:6144
  ds_read_b128 v[196:199], v243 offset:8192
  ds_read_b128 v[200:203], v243 offset:10240
  ds_read_b128 v[204:207], v243 offset:12288
  ds_read_b128 v[208:211], v243 offset:14336
  ds_read_b128 v[212:215], v243 offset:16384
  ds_read_b128 v[216:219], v243 offset:18432
  s_waitcnt lgkmcnt(0)
  v_add_f32 v188, v188, v204
  v_add_f32 v189, v189, v205
  v_add_f32 v190, v190, v206
  v_add_f32 v191, v191, v207
  v_add_f32 v192, v192, v208
  v_add_f32 v193, v193, v209
  v_add_f32 v194, v194, v210
  v_add_f32 v195, v195, v211
  v_add_f32 v196, v196, v212
  v_add_f32 v197, v197, v213
  v_add_f32 v198, v198, v214
  v_add_f32 v199, v199, v215
  v_add_f32 v200, v200, v216
  v_add_f32 v201, v201, v217
  v_add_f32 v202, v202, v218
  v_add_f32 v203, v203, v219
  v_add_f32 v188, v188, v196
  v_add_f32 v189, v189, v197
  v_add_f32 v190, v190, v198
  v_add_f32 v191, v191, v199
  v_add_f32 v192, v192, v200
  v_add_f32 v193, v193, v201
  v_add_f32 v194, v194, v202
  v_add_f32 v195, v195, v203
  v_add_f32 v188, v188, v192
  v_add_f32 v189, v189, v193
  v_add_f32 v190, v190, v194
  v_add_f32 v191, v191, v195
  buffer_store_dwordx4 v[188:191], v244, s[72:75], 0 offen offset:0 sc1
  s_cmp_eq_u32 s3, 0
  s_cbranch_scc0 gated_mix__mha_block_cached__gqa_block_cached__decode_kernel_done
  s_waitcnt vmcnt(0)
  s_branch gated_mix__mha_block_cached__gqa_block_cached__decode_kernel_fin
gated_mix__mha_block_cached__gqa_block_cached__decode_kernel_noy:
  s_branch gated_mix__mha_block_cached__gqa_block_cached__decode_kernel_done
gated_mix__mha_block_cached__gqa_block_cached__decode_kernel_fin:
  s_mov_b32 s93, 0
gated_mix__mha_block_cached__gqa_block_cached__decode_kernel_p2:
  buffer_load_dwordx4 v[180:183], v245, s[72:75], 0 offen offset:0 sc1
  buffer_load_dwordx4 v[184:187], v245, s[72:75], 0 offen offset:16 sc1
  s_waitcnt vmcnt(0)
  v_max3_u32 v14, v180, v181, v182
  v_max3_u32 v15, v183, v184, v185
  v_max3_u32 v14, v14, v186, v187
  v_max_u32 v14, v14, v15
  v_cmp_eq_u32 vcc, -1, v14
  s_nop 1
  s_cmp_eq_u64 vcc, 0
  s_cbranch_scc1 gated_mix__mha_block_cached__gqa_block_cached__decode_kernel_p2d
  s_add_u32 s93, s93, 1
  s_cmp_gt_u32 s93, 200000
  s_cbranch_scc1 gated_mix__mha_block_cached__gqa_block_cached__decode_kernel_p2d
  s_sleep 4
  s_branch gated_mix__mha_block_cached__gqa_block_cached__decode_kernel_p2
gated_mix__mha_block_cached__gqa_block_cached__decode_kernel_p2d:
  v_permlane32_swap_b32 v180, v181
  v_permlane32_swap_b32 v182, v183
  v_permlane32_swap_b32 v184, v185
  v_permlane32_swap_b32 v186, v187
  v_add_f32 v180, v180, v181
  v_add_f32 v182, v182, v183
  v_add_f32 v184, v184, v185
  v_add_f32 v186, v186, v187
  v_permlane16_swap_b32 v180, v182
  s_nop 0
  v_permlane16_swap_b32 v184, v186
  v_add_f32 v180, v180, v182
  v_add_f32 v184, v184, v186
  s_nop 0
  v_add_f32_dpp v180, v180, v180 row_ror:8 row_mask:0xf bank_mask:0xf
  v_add_f32_dpp v184, v184, v184 row_ror:8 row_mask:0xf bank_mask:0xf
  s_nop 0
  v_add_f32_dpp v180, v180, v180 row_ror:4 row_mask:0xf bank_mask:0xf
  v_add_f32_dpp v184, v184, v184 row_ror:4 row_mask:0xf bank_mask:0xf
  s_nop 0
  v_add_f32_dpp v180, v180, v180 row_ror:2 row_mask:0xf bank_mask:0xf
  v_add_f32_dpp v184, v184, v184 row_ror:2 row_mask:0xf bank_mask:0xf
  s_nop 0
  v_add_f32_dpp v180, v180, v180 row_ror:1 row_mask:0xf bank_mask:0xf
  v_add_f32_dpp v184, v184, v184 row_ror:1 row_mask:0xf bank_mask:0xf
  v_cvt_pk_bf16_f32 v180, v180, v184
  s_mov_b32 exec_lo, 0x00010001
  s_mov_b32 exec_hi, 0x00010001
  buffer_store_short v180, v246, s[76:79], 0 offen
  buffer_store_short_d16_hi v180, v246, s[76:79], 0 offen offset:8
  s_mov_b64 exec, -1
  s_branch gated_mix__mha_block_cached__gqa_block_cached__decode_kernel_done
gated_mix__mha_block_cached__gqa_block_cached__decode_kernel_job0:
  s_add_u32 s85, s2, 0
  s_and_b32 s85, s85, 7
  s_cmp_eq_u32 s3, s85
  s_cbranch_scc0 gated_mix__mha_block_cached__gqa_block_cached__decode_kernel_jobret
  s_waitcnt vmcnt(8)
  s_mov_b32 s85, 1
  s_atomic_add s85, s[28:29], 0x0
  s_waitcnt lgkmcnt(0)
  s_branch gated_mix__mha_block_cached__gqa_block_cached__decode_kernel_jobret
gated_mix__mha_block_cached__gqa_block_cached__decode_kernel_job2:
  s_add_u32 s85, s2, 3
  s_and_b32 s85, s85, 7
  s_cmp_eq_u32 s3, s85
  s_cbranch_scc0 gated_mix__mha_block_cached__gqa_block_cached__decode_kernel_jobret
  v_lshlrev_b32 v15, 6, v13
  v_lshl_add_u32 v14, v10, 10, v15
  buffer_load_dwordx4 v[164:167], v14, s[64:67], 0 offen offset:0
  buffer_load_dwordx4 v[180:183], v15, s[68:71], 0 offen offset:0
  buffer_load_dwordx4 v[168:171], v14, s[64:67], 0 offen offset:16
  buffer_load_dwordx4 v[184:187], v15, s[68:71], 0 offen offset:16
  buffer_load_dwordx4 v[172:175], v14, s[64:67], 0 offen offset:32
  buffer_load_dwordx4 v[188:191], v15, s[68:71], 0 offen offset:32
  buffer_load_dwordx4 v[176:179], v14, s[64:67], 0 offen offset:48
  buffer_load_dwordx4 v[192:195], v15, s[68:71], 0 offen offset:48
  s_waitcnt vmcnt(0)
  v_mov_b32 v196, 0
  v_lshlrev_b32 v197, 16, v164
  v_lshlrev_b32 v198, 16, v180
  v_and_b32 v199, 0xffff0000, v164
  v_and_b32 v200, 0xffff0000, v180
  v_mul_f32 v197, v197, v198
  v_mul_f32 v199, v199, v200
  v_cvt_pk_bf16_f32 v197, v197, v199
  v_lshlrev_b32 v198, 16, v197
  v_and_b32 v197, 0xffff0000, v197
  v_add_f32 v196, v196, v198
  v_add_f32 v196, v196, v197
  v_lshlrev_b32 v197, 16, v165
  v_lshlrev_b32 v198, 16, v181
  v_and_b32 v199, 0xffff0000, v165
  v_and_b32 v200, 0xffff0000, v181
  v_mul_f32 v197, v197, v198
  v_mul_f32 v199, v199, v200
  v_cvt_pk_bf16_f32 v197, v197, v199
  v_lshlrev_b32 v198, 16, v197
  v_and_b32 v197, 0xffff0000, v197
  v_add_f32 v196, v196, v198
  v_add_f32 v196, v196, v197
  v_lshlrev_b32 v197, 16, v166
  v_lshlrev_b32 v198, 16, v182
  v_and_b32 v199, 0xffff0000, v166
  v_and_b32 v200, 0xffff0000, v182
  v_mul_f32 v197, v197, v198
  v_mul_f32 v199, v199, v200
  v_cvt_pk_bf16_f32 v197, v197, v199
  v_lshlrev_b32 v198, 16, v197
  v_and_b32 v197, 0xffff0000, v197
  v_add_f32 v196, v196, v198
  v_add_f32 v196, v196, v197
  v_lshlrev_b32 v197, 16, v167
  v_lshlrev_b32 v198, 16, v183
  v_and_b32 v199, 0xffff0000, v167
  v_and_b32 v200, 0xffff0000, v183
  v_mul_f32 v197, v197, v198
  v_mul_f32 v199, v199, v200
  v_cvt_pk_bf16_f32 v197, v197, v199
  v_lshlrev_b32 v198, 16, v197
  v_and_b32 v197, 0xffff0000, v197
  v_add_f32 v196, v196, v198
  v_add_f32 v196, v196, v197
  v_lshlrev_b32 v197, 16, v168
  v_lshlrev_b32 v198, 16, v184
  v_and_b32 v199, 0xffff0000, v168
  v_and_b32 v200, 0xffff0000, v184
  v_mul_f32 v197, v197, v198
  v_mul_f32 v199, v199, v200
  v_cvt_pk_bf16_f32 v197, v197, v199
  v_lshlrev_b32 v198, 16, v197
  v_and_b32 v197, 0xffff0000, v197
  v_add_f32 v196, v196, v198
  v_add_f32 v196, v196, v197
  v_lshlrev_b32 v197, 16, v169
  v_lshlrev_b32 v198, 16, v185
  v_and_b32 v199, 0xffff0000, v169
  v_and_b32 v200, 0xffff0000, v185
  v_mul_f32 v197, v197, v198
  v_mul_f32 v199, v199, v200
  v_cvt_pk_bf16_f32 v197, v197, v199
  v_lshlrev_b32 v198, 16, v197
  v_and_b32 v197, 0xffff0000, v197
  v_add_f32 v196, v196, v198
  v_add_f32 v196, v196, v197
  v_lshlrev_b32 v197, 16, v170
  v_lshlrev_b32 v198, 16, v186
  v_and_b32 v199, 0xffff0000, v170
  v_and_b32 v200, 0xffff0000, v186
  v_mul_f32 v197, v197, v198
  v_mul_f32 v199, v199, v200
  v_cvt_pk_bf16_f32 v197, v197, v199
  v_lshlrev_b32 v198, 16, v197
  v_and_b32 v197, 0xffff0000, v197
  v_add_f32 v196, v196, v198
  v_add_f32 v196, v196, v197
  v_lshlrev_b32 v197, 16, v171
  v_lshlrev_b32 v198, 16, v187
  v_and_b32 v199, 0xffff0000, v171
  v_and_b32 v200, 0xffff0000, v187
  v_mul_f32 v197, v197, v198
  v_mul_f32 v199, v199, v200
  v_cvt_pk_bf16_f32 v197, v197, v199
  v_lshlrev_b32 v198, 16, v197
  v_and_b32 v197, 0xffff0000, v197
  v_add_f32 v196, v196, v198
  v_add_f32 v196, v196, v197
  v_lshlrev_b32 v197, 16, v172
  v_lshlrev_b32 v198, 16, v188
  v_and_b32 v199, 0xffff0000, v172
  v_and_b32 v200, 0xffff0000, v188
  v_mul_f32 v197, v197, v198
  v_mul_f32 v199, v199, v200
  v_cvt_pk_bf16_f32 v197, v197, v199
  v_lshlrev_b32 v198, 16, v197
  v_and_b32 v197, 0xffff0000, v197
  v_add_f32 v196, v196, v198
  v_add_f32 v196, v196, v197
  v_lshlrev_b32 v197, 16, v173
  v_lshlrev_b32 v198, 16, v189
  v_and_b32 v199, 0xffff0000, v173
  v_and_b32 v200, 0xffff0000, v189
  v_mul_f32 v197, v197, v198
  v_mul_f32 v199, v199, v200
  v_cvt_pk_bf16_f32 v197, v197, v199
  v_lshlrev_b32 v198, 16, v197
  v_and_b32 v197, 0xffff0000, v197
  v_add_f32 v196, v196, v198
  v_add_f32 v196, v196, v197
  v_lshlrev_b32 v197, 16, v174
  v_lshlrev_b32 v198, 16, v190
  v_and_b32 v199, 0xffff0000, v174
  v_and_b32 v200, 0xffff0000, v190
  v_mul_f32 v197, v197, v198
  v_mul_f32 v199, v199, v200
  v_cvt_pk_bf16_f32 v197, v197, v199
  v_lshlrev_b32 v198, 16, v197
  v_and_b32 v197, 0xffff0000, v197
  v_add_f32 v196, v196, v198
  v_add_f32 v196, v196, v197
  v_lshlrev_b32 v197, 16, v175
  v_lshlrev_b32 v198, 16, v191
  v_and_b32 v199, 0xffff0000, v175
  v_and_b32 v200, 0xffff0000, v191
  v_mul_f32 v197, v197, v198
  v_mul_f32 v199, v199, v200
  v_cvt_pk_bf16_f32 v197, v197, v199
  v_lshlrev_b32 v198, 16, v197
  v_and_b32 v197, 0xffff0000, v197
  v_add_f32 v196, v196, v198
  v_add_f32 v196, v196, v197
  v_lshlrev_b32 v197, 16, v176
  v_lshlrev_b32 v198, 16, v192
  v_and_b32 v199, 0xffff0000, v176
  v_and_b32 v200, 0xffff0000, v192
  v_mul_f32 v197, v197, v198
  v_mul_f32 v199, v199, v200
  v_cvt_pk_bf16_f32 v197, v197, v199
  v_lshlrev_b32 v198, 16, v197
  v_and_b32 v197, 0xffff0000, v197
  v_add_f32 v196, v196, v198
  v_add_f32 v196, v196, v197
  v_lshlrev_b32 v197, 16, v177
  v_lshlrev_b32 v198, 16, v193
  v_and_b32 v199, 0xffff0000, v177
  v_and_b32 v200, 0xffff0000, v193
  v_mul_f32 v197, v197, v198
  v_mul_f32 v199, v199, v200
  v_cvt_pk_bf16_f32 v197, v197, v199
  v_lshlrev_b32 v198, 16, v197
  v_and_b32 v197, 0xffff0000, v197
  v_add_f32 v196, v196, v198
  v_add_f32 v196, v196, v197
  v_lshlrev_b32 v197, 16, v178
  v_lshlrev_b32 v198, 16, v194
  v_and_b32 v199, 0xffff0000, v178
  v_and_b32 v200, 0xffff0000, v194
  v_mul_f32 v197, v197, v198
  v_mul_f32 v199, v199, v200
  v_cvt_pk_bf16_f32 v197, v197, v199
  v_lshlrev_b32 v198, 16, v197
  v_and_b32 v197, 0xffff0000, v197
  v_add_f32 v196, v196, v198
  v_add_f32 v196, v196, v197
  v_lshlrev_b32 v197, 16, v179
  v_lshlrev_b32 v198, 16, v195
  v_and_b32 v199, 0xffff0000, v179
  v_and_b32 v200, 0xffff0000, v195
  v_mul_f32 v197, v197, v198
  v_mul_f32 v199, v199, v200
  v_cvt_pk_bf16_f32 v197, v197, v199
  v_lshlrev_b32 v198, 16, v197
  v_and_b32 v197, 0xffff0000, v197
  v_add_f32 v196, v196, v198
  v_add_f32 v196, v196, v197
  s_nop 1
  v_add_f32_dpp v196, v196, v196 row_ror:8 row_mask:0xf bank_mask:0xf
  s_nop 1
  v_add_f32_dpp v196, v196, v196 row_ror:4 row_mask:0xf bank_mask:0xf
  s_nop 1
  v_add_f32_dpp v196, v196, v196 row_ror:2 row_mask:0xf bank_mask:0xf
  s_nop 1
  v_add_f32_dpp v196, v196, v196 row_ror:1 row_mask:0xf bank_mask:0xf
  v_cvt_pk_bf16_f32 v196, v196, v196
  v_and_b32 v196, 0xffff0000, v196
  v_mul_f32 v196, s92, v196
  v_exp_f32 v196, v196
  s_nop 0
  v_add_f32 v196, 1.0, v196
  v_rcp_f32 v196, v196
  s_nop 0
  v_cvt_pk_bf16_f32 v202, v196, v196
  v_and_b32 v202, 0xffff0000, v202
  v_sub_f32 v203, 1.0, v202
  v_cvt_pk_bf16_f32 v203, v203, v203
  v_and_b32 v203, 0xffff0000, v203
  v_lshlrev_b32 v14, 3, v10
  ds_write_b64 v14, v[202:203] offset:3584
  s_waitcnt lgkmcnt(0)
  s_nop 7
  s_branch gated_mix__mha_block_cached__gqa_block_cached__decode_kernel_jobret
gated_mix__mha_block_cached__gqa_block_cached__decode_kernel_jobp:
  s_add_u32 s85, s2, 5
  s_and_b32 s85, s85, 7
  s_cmp_eq_u32 s3, s85
  s_cbranch_scc0 gated_mix__mha_block_cached__gqa_block_cached__decode_kernel_jobret
  v_mov_b32 v14, 0
  global_load_dword v7, v14, s[28:29] sc1
  s_branch gated_mix__mha_block_cached__gqa_block_cached__decode_kernel_jobret
gated_mix__mha_block_cached__gqa_block_cached__decode_kernel_jobg:
  s_add_u32 s85, s2, 5
  s_and_b32 s85, s85, 7
  s_cmp_eq_u32 s3, s85
  s_cbranch_scc0 gated_mix__mha_block_cached__gqa_block_cached__decode_kernel_jobret
  s_mov_b32 s93, 0
  s_waitcnt vmcnt(16)
gated_mix__mha_block_cached__gqa_block_cached__decode_kernel_c0:
  v_readfirstlane_b32 s85, v7
  s_nop 1
  s_cmp_ge_u32 s85, 256
  s_cbranch_scc1 gated_mix__mha_block_cached__gqa_block_cached__decode_kernel_c0d
  s_add_u32 s93, s93, 1
  s_cmp_gt_u32 s93, 200000
  s_cbranch_scc1 gated_mix__mha_block_cached__gqa_block_cached__decode_kernel_c0d
  s_sleep 16
  v_mov_b32 v14, 0
  global_load_dword v7, v14, s[28:29] sc1
  s_waitcnt vmcnt(0)
  s_branch gated_mix__mha_block_cached__gqa_block_cached__decode_kernel_c0
gated_mix__mha_block_cached__gqa_block_cached__decode_kernel_c0d:
  s_lshr_b32 s85, s2, 3
  s_and_b32 s85, s85, 7
  s_lshl_b32 s85, s85, 16
  s_lshl_b32 s86, s80, 9
  s_add_u32 s85, s85, s86
  s_add_u32 s85, s85, 2097152
  v_lshlrev_b32 v14, 14, v11
  v_lshl_add_u32 v14, v10, 7, v14
  v_lshl_add_u32 v14, v12, 5, v14
  v_add_u32 v14, s85, v14
  s_mov_b32 s86, 0
  buffer_load_dwordx4 v[164:167], v14, s[72:75], s86 offen offset:0 sc1
  buffer_load_dwordx4 v[168:171], v14, s[72:75], s86 offen offset:16 sc1
  s_mov_b32 s86, 0
  buffer_load_dwordx4 v[172:175], v14, s[72:75], s86 offen offset:2048 sc1
  buffer_load_dwordx4 v[176:179], v14, s[72:75], s86 offen offset:2064 sc1
  s_mov_b32 s86, 4096
  buffer_load_dwordx4 v[180:183], v14, s[72:75], s86 offen offset:0 sc1
  buffer_load_dwordx4 v[184:187], v14, s[72:75], s86 offen offset:16 sc1
  s_mov_b32 s86, 4096
  buffer_load_dwordx4 v[188:191], v14, s[72:75], s86 offen offset:2048 sc1
  buffer_load_dwordx4 v[192:195], v14, s[72:75], s86 offen offset:2064 sc1
  s_mov_b32 s86, 8192
  buffer_load_dwordx4 v[196:199], v14, s[72:75], s86 offen offset:0 sc1
  buffer_load_dwordx4 v[200:203], v14, s[72:75], s86 offen offset:16 sc1
  s_mov_b32 s86, 8192
  buffer_load_dwordx4 v[204:207], v14, s[72:75], s86 offen offset:2048 sc1
  buffer_load_dwordx4 v[208:211], v14, s[72:75], s86 offen offset:2064 sc1
  s_mov_b32 s86, 12288
  buffer_load_dwordx4 v[212:215], v14, s[72:75], s86 offen offset:0 sc1
  buffer_load_dwordx4 v[216:219], v14, s[72:75], s86 offen offset:16 sc1
  s_mov_b32 s86, 12288
  buffer_load_dwordx4 v[220:223], v14, s[72:75], s86 offen offset:2048 sc1
  buffer_load_dwordx4 v[224:227], v14, s[72:75], s86 offen offset:2064 sc1
  s_waitcnt vmcnt(0)
  v_add_f32 v164, v164, v196
  v_add_f32 v165, v165, v197
  v_add_f32 v166, v166, v198
  v_add_f32 v167, v167, v199
  v_add_f32 v168, v168, v200
  v_add_f32 v169, v169, v201
  v_add_f32 v170, v170, v202
  v_add_f32 v171, v171, v203
  v_add_f32 v172, v172, v204
  v_add_f32 v173, v173, v205
  v_add_f32 v174, v174, v206
  v_add_f32 v175, v175, v207
  v_add_f32 v176, v176, v208
  v_add_f32 v177, v177, v209
  v_add_f32 v178, v178, v210
  v_add_f32 v179, v179, v211
  v_add_f32 v180, v180, v212
  v_add_f32 v181, v181, v213
  v_add_f32 v182, v182, v214
  v_add_f32 v183, v183, v215
  v_add_f32 v184, v184, v216
  v_add_f32 v185, v185, v217
  v_add_f32 v186, v186, v218
  v_add_f32 v187, v187, v219
  v_add_f32 v188, v188, v220
  v_add_f32 v189, v189, v221
  v_add_f32 v190, v190, v222
  v_add_f32 v191, v191, v223
  v_add_f32 v192, v192, v224
  v_add_f32 v193, v193, v225
  v_add_f32 v194, v194, v226
  v_add_f32 v195, v195, v227
  v_add_f32 v164, v164, v180
  v_add_f32 v165, v165, v181
  v_add_f32 v166, v166, v182
  v_add_f32 v167, v167, v183
  v_add_f32 v168, v168, v184
  v_add_f32 v169, v169, v185
  v_add_f32 v170, v170, v186
  v_add_f32 v171, v171, v187
  v_add_f32 v172, v172, v188
  v_add_f32 v173, v173, v189
  v_add_f32 v174, v174, v190
  v_add_f32 v175, v175, v191
  v_add_f32 v176, v176, v192
  v_add_f32 v177, v177, v193
  v_add_f32 v178, v178, v194
  v_add_f32 v179, v179, v195
  v_add_f32 v164, v164, v172
  v_add_f32 v165, v165, v173
  v_add_f32 v166, v166, v174
  v_add_f32 v167, v167, v175
  v_add_f32 v168, v168, v176
  v_add_f32 v169, v169, v177
  v_add_f32 v170, v170, v178
  v_add_f32 v171, v171, v179
  v_cvt_pk_bf16_f32 v172, v164, v165
  v_cvt_pk_bf16_f32 v173, v166, v167
  v_cvt_pk_bf16_f32 v174, v168, v169
  v_cvt_pk_bf16_f32 v175, v170, v171
  ds_write_b128 v2, v[172:175] offset:0
  s_waitcnt lgkmcnt(0)
  v_mov_b32 v14, 3648
  ds_write_b32 v14, v8
  s_waitcnt lgkmcnt(0)
  s_nop 7
  s_branch gated_mix__mha_block_cached__gqa_block_cached__decode_kernel_jobret
gated_mix__mha_block_cached__gqa_block_cached__decode_kernel_done:
  s_endpgm

.section .rodata,"a"
.p2align 6
.amdhsa_kernel gated_mix__mha_block_cached__gqa_block_cached__decode_kernel
  .amdhsa_next_free_vgpr 256
  .amdhsa_next_free_sgpr 102
  .amdhsa_accum_offset 256
  .amdhsa_group_segment_fixed_size 0
  .amdhsa_kernarg_size 112
  .amdhsa_user_sgpr_count 2
  .amdhsa_user_sgpr_kernarg_segment_ptr 1
  .amdhsa_system_sgpr_workgroup_id_x 1
  .amdhsa_float_denorm_mode_32 3
.end_amdhsa_kernel
```
